```python
import torch

def _softmax(x, axis=-1):
    return torch.softmax(x, dim=axis)
def _gelu(x):
    return torch.nn.functional.gelu(x, approximate="tanh")
def _silu(x):
    return torch.nn.functional.silu(x)
def _sigmoid(x):
    return torch.sigmoid(x)
def _layernorm(x, axis=-1, eps=1e-5):
    m = x.mean(dim=axis, keepdim=True)
    v = x.var(dim=axis, keepdim=True, unbiased=False)
    return (x - m) / torch.sqrt(v + eps)
def _scatter_add(tgt, idx, src, axis=0):
    return tgt.clone().index_add_(axis, idx, src)
def _segment_sum(src, seg, n):
    out = torch.zeros((n,) + src.shape[1:], dtype=src.dtype)
    return out.index_add_(0, seg, src)
def _pad(x, pw):
    flat = tuple(v for pair in reversed(pw) for v in pair)
    return torch.nn.functional.pad(x, flat)

kernel_name = 'sequential_preLN__spectral_fnet__moe_arch_mod__prompt'

def setup_inputs():

    _w = (lambda a: (lambda t: t.to(torch.bfloat16) if t.is_floating_point() else t)(torch.as_tensor(a)))
    def _A_setup():
        B, S, D = 1, 2048, 640
        ns = torch.arange(S)[:, None] * torch.arange(S)[None, :]
        nd = torch.arange(D)[:, None] * torch.arange(D)[None, :]
        Ws_re = torch.cos(-2.0 * torch.pi * ns / S).to(float)
        Ws_im = torch.sin(-2.0 * torch.pi * ns / S).to(float)
        Wd_re = torch.cos(-2.0 * torch.pi * nd / D).to(float)
        Wd_im = torch.sin(-2.0 * torch.pi * nd / D).to(float)
        return {
            "x": _w((lambda *s: torch.randn(*s, dtype=torch.bfloat16) * 0.1)(B, S, D)),
            "dft_seq_re": _w(Ws_re),
            "dft_seq_im": _w(Ws_im),
            "dft_hid_re": _w(Wd_re),
            "dft_hid_im": _w(Wd_im),
        }
    _A_in = _A_setup()

    def _B_setup():
        B, S, D, F, C = 1, 2048, 640, 1536, 8
        return {
            "x": _w((lambda *s: torch.randn(*s, dtype=torch.bfloat16) * 0.1)(B, S, D)),
            "w_r": _w((lambda *s: torch.randn(*s, dtype=torch.bfloat16) * 1.6)(D)),
            "w_gate": _w((lambda *s: torch.randn(*s, dtype=torch.bfloat16) * 0.8)(D, F)),
            "w_up": _w((lambda *s: torch.randn(*s, dtype=torch.bfloat16) * 0.8)(D, F)),
            "w_down": _w((lambda *s: torch.randn(*s, dtype=torch.bfloat16) * 0.8)(F, D)),
        }
    _B_in = _B_setup()

    return {
        "A_x": _A_in["x"],
        "A_dft_seq_re": _A_in["dft_seq_re"],
        "A_dft_seq_im": _A_in["dft_seq_im"],
        "A_dft_hid_re": _A_in["dft_hid_re"],
        "A_dft_hid_im": _A_in["dft_hid_im"],
        "B_x": _B_in["x"],
        "B_w_r": _B_in["w_r"],
        "B_w_gate": _B_in["w_gate"],
        "B_w_up": _B_in["w_up"],
        "B_w_down": _B_in["w_down"],
    }

def reference(A_x, A_dft_seq_re, A_dft_seq_im, A_dft_hid_re, A_dft_hid_im, B_x, B_w_r, B_w_gate, B_w_up, B_w_down):
    def _A_ref(x, dft_seq_re, dft_seq_im, dft_hid_re, dft_hid_im):
        a = torch.einsum("bsd,ed->bse", x, dft_hid_re)
        b = torch.einsum("bsd,ed->bse", x, dft_hid_im)
        y = torch.einsum("ts,bse->bte", dft_seq_re, a) - torch.einsum("ts,bse->bte", dft_seq_im, b)
        return y

    def _B_ref(x, w_r, w_gate, w_up, w_down):
        B, S, D = x.shape
        C = 8
        r = x @ w_r
        idx = torch.argsort(-r, axis=-1)[:, :C]
        idx_e = (lambda x, n, axis: torch.repeat_interleave(x, n, dim=axis))(idx.reshape(B, C, 1), D, axis=2)
        x_sel = (lambda x, i, axis: torch.take_along_dim(x, i, dim=axis))(x, idx_e, axis=1)
        g = _silu(x_sel @ w_gate)
        u = x_sel @ w_up
        y = (g * u) @ w_down
        r_sel = _sigmoid((lambda x, i, axis: torch.take_along_dim(x, i, dim=axis))(r, idx, axis=1))
        y = y * r_sel.reshape(B, C, 1)
        b_off = (torch.arange(B) * S).reshape(B, 1)
        flat_idx = (idx + b_off).reshape(B * C)
        zero = (x * 0.0).reshape(B * S, D)
        upd = _scatter_add(zero, flat_idx, y.reshape(B * C, D), axis=0)
        return x + upd.reshape(B, S, D)

    x = A_x
    h = x + _A_ref(_layernorm(x, axis=-1), A_dft_seq_re, A_dft_seq_im, A_dft_hid_re, A_dft_hid_im)
    h2 = h + _B_ref(_layernorm(h, axis=-1), B_w_r, B_w_gate, B_w_up, B_w_down)
    return h2
```

```asm
; @launch kernel=lnx_kernel grid=(512,1,1) block=(256,1,1) lds=0
; @launch kernel=g1_kernel grid=(256,1,1) block=(256,1,1) lds=159744
; @launch kernel=g2_kernel grid=(256,1,1) block=(256,1,1) lds=147456
; @launch kernel=ln2_kernel grid=(512,1,1) block=(256,1,1) lds=0
; @launch kernel=ffn1_kernel grid=(96,1,1) block=(256,1,1) lds=29696
.amdgcn_target "amdgcn-amd-amdhsa--gfx950"
.text
.globl lnx_kernel
.p2align 8
.type lnx_kernel,@function
lnx_kernel:
    s_cmp_ge_u32 s2, 512
    s_cbranch_scc1 lnx_kernel_done
    s_load_dwordx2 s[4:5], s[0:1], 0
    s_load_dwordx2 s[6:7], s[0:1], 96
    v_lshrrev_b32 v1, 6, v0
    s_lshl_b32 s3, s2, 2
    v_add_u32 v1, s3, v1
    v_mul_u32_u24 v1, 1280, v1
    v_and_b32 v2, 63, v0
    v_lshl_add_u32 v1, v2, 2, v1
    s_waitcnt lgkmcnt(0)
    s_mov_b32 s8, s4
    s_mov_b32 s9, s5
    s_mov_b32 s10, 0x280000
    s_mov_b32 s11, 0x00020000
    s_mov_b32 s12, s6
    s_mov_b32 s13, s7
    s_mov_b32 s14, 0x280000
    s_mov_b32 s15, 0x00020000
    buffer_load_dword v10, v1, s[8:11], 0 offen offset:0
    buffer_load_dword v11, v1, s[8:11], 0 offen offset:256
    buffer_load_dword v12, v1, s[8:11], 0 offen offset:512
    buffer_load_dword v13, v1, s[8:11], 0 offen offset:768
    buffer_load_dword v14, v1, s[8:11], 0 offen offset:1024
    s_waitcnt vmcnt(0)
    v_lshlrev_b32 v20, 16, v10
    v_and_b32 v21, 0xffff0000, v10
    v_lshlrev_b32 v22, 16, v11
    v_and_b32 v23, 0xffff0000, v11
    v_lshlrev_b32 v24, 16, v12
    v_and_b32 v25, 0xffff0000, v12
    v_lshlrev_b32 v26, 16, v13
    v_and_b32 v27, 0xffff0000, v13
    v_lshlrev_b32 v28, 16, v14
    v_and_b32 v29, 0xffff0000, v14
    v_add_f32 v40, v20, v21
    v_add_f32 v40, v40, v22
    v_add_f32 v40, v40, v23
    v_add_f32 v40, v40, v24
    v_add_f32 v40, v40, v25
    v_add_f32 v40, v40, v26
    v_add_f32 v40, v40, v27
    v_add_f32 v40, v40, v28
    v_add_f32 v40, v40, v29
    s_nop 1
    v_add_f32_dpp v40, v40, v40 quad_perm:[1,0,3,2] row_mask:0xf bank_mask:0xf
    s_nop 1
    v_add_f32_dpp v40, v40, v40 quad_perm:[2,3,0,1] row_mask:0xf bank_mask:0xf
    s_nop 1
    v_add_f32_dpp v40, v40, v40 row_half_mirror row_mask:0xf bank_mask:0xf
    s_nop 1
    v_add_f32_dpp v40, v40, v40 row_mirror row_mask:0xf bank_mask:0xf
    s_nop 1
    v_add_f32_dpp v40, v40, v40 row_bcast:15 row_mask:0xa bank_mask:0xf
    s_nop 1
    v_add_f32_dpp v40, v40, v40 row_bcast:31 row_mask:0xc bank_mask:0xf
    s_nop 0
    v_readlane_b32 s20, v40, 63
    s_nop 1
    v_mov_b32 v41, s20
    v_mul_f32 v41, 0x3acccccd, v41
    v_mov_b32 v42, 0
    v_sub_f32 v43, v20, v41
    v_fmac_f32 v42, v43, v43
    v_sub_f32 v43, v21, v41
    v_fmac_f32 v42, v43, v43
    v_sub_f32 v43, v22, v41
    v_fmac_f32 v42, v43, v43
    v_sub_f32 v43, v23, v41
    v_fmac_f32 v42, v43, v43
    v_sub_f32 v43, v24, v41
    v_fmac_f32 v42, v43, v43
    v_sub_f32 v43, v25, v41
    v_fmac_f32 v42, v43, v43
    v_sub_f32 v43, v26, v41
    v_fmac_f32 v42, v43, v43
    v_sub_f32 v43, v27, v41
    v_fmac_f32 v42, v43, v43
    v_sub_f32 v43, v28, v41
    v_fmac_f32 v42, v43, v43
    v_sub_f32 v43, v29, v41
    v_fmac_f32 v42, v43, v43
    s_nop 1
    v_add_f32_dpp v42, v42, v42 quad_perm:[1,0,3,2] row_mask:0xf bank_mask:0xf
    s_nop 1
    v_add_f32_dpp v42, v42, v42 quad_perm:[2,3,0,1] row_mask:0xf bank_mask:0xf
    s_nop 1
    v_add_f32_dpp v42, v42, v42 row_half_mirror row_mask:0xf bank_mask:0xf
    s_nop 1
    v_add_f32_dpp v42, v42, v42 row_mirror row_mask:0xf bank_mask:0xf
    s_nop 1
    v_add_f32_dpp v42, v42, v42 row_bcast:15 row_mask:0xa bank_mask:0xf
    s_nop 1
    v_add_f32_dpp v42, v42, v42 row_bcast:31 row_mask:0xc bank_mask:0xf
    s_nop 0
    v_readlane_b32 s20, v42, 63
    s_nop 1
    v_mov_b32 v42, s20
    v_mul_f32 v42, 0x3acccccd, v42
    v_cvt_pk_bf16_f32 v41, v41, v41
    v_lshlrev_b32 v41, 16, v41
    v_cvt_pk_bf16_f32 v42, v42, v42
    v_lshlrev_b32 v42, 16, v42
    v_add_f32 v42, 0x3727c5ac, v42
    v_cvt_pk_bf16_f32 v42, v42, v42
    v_lshlrev_b32 v42, 16, v42
    v_sqrt_f32 v42, v42
    s_nop 0
    v_cvt_pk_bf16_f32 v42, v42, v42
    v_lshlrev_b32 v42, 16, v42
    v_rcp_f32 v43, v42
    s_nop 0
    v_sub_f32 v44, v20, v41
    v_sub_f32 v45, v21, v41
    v_cvt_pk_bf16_f32 v44, v44, v45
    v_lshlrev_b32 v30, 16, v44
    v_and_b32 v31, 0xffff0000, v44
    v_sub_f32 v44, v22, v41
    v_sub_f32 v45, v23, v41
    v_cvt_pk_bf16_f32 v44, v44, v45
    v_lshlrev_b32 v32, 16, v44
    v_and_b32 v33, 0xffff0000, v44
    v_sub_f32 v44, v24, v41
    v_sub_f32 v45, v25, v41
    v_cvt_pk_bf16_f32 v44, v44, v45
    v_lshlrev_b32 v34, 16, v44
    v_and_b32 v35, 0xffff0000, v44
    v_sub_f32 v44, v26, v41
    v_sub_f32 v45, v27, v41
    v_cvt_pk_bf16_f32 v44, v44, v45
    v_lshlrev_b32 v36, 16, v44
    v_and_b32 v37, 0xffff0000, v44
    v_sub_f32 v44, v28, v41
    v_sub_f32 v45, v29, v41
    v_cvt_pk_bf16_f32 v44, v44, v45
    v_lshlrev_b32 v38, 16, v44
    v_and_b32 v39, 0xffff0000, v44
    v_mul_f32 v44, v30, v43
    v_fma_f32 v45, -v44, v42, v30
    v_fma_f32 v30, v45, v43, v44
    v_mul_f32 v44, v31, v43
    v_fma_f32 v45, -v44, v42, v31
    v_fma_f32 v31, v45, v43, v44
    v_mul_f32 v44, v32, v43
    v_fma_f32 v45, -v44, v42, v32
    v_fma_f32 v32, v45, v43, v44
    v_mul_f32 v44, v33, v43
    v_fma_f32 v45, -v44, v42, v33
    v_fma_f32 v33, v45, v43, v44
    v_mul_f32 v44, v34, v43
    v_fma_f32 v45, -v44, v42, v34
    v_fma_f32 v34, v45, v43, v44
    v_mul_f32 v44, v35, v43
    v_fma_f32 v45, -v44, v42, v35
    v_fma_f32 v35, v45, v43, v44
    v_mul_f32 v44, v36, v43
    v_fma_f32 v45, -v44, v42, v36
    v_fma_f32 v36, v45, v43, v44
    v_mul_f32 v44, v37, v43
    v_fma_f32 v45, -v44, v42, v37
    v_fma_f32 v37, v45, v43, v44
    v_mul_f32 v44, v38, v43
    v_fma_f32 v45, -v44, v42, v38
    v_fma_f32 v38, v45, v43, v44
    v_mul_f32 v44, v39, v43
    v_fma_f32 v45, -v44, v42, v39
    v_fma_f32 v39, v45, v43, v44
    v_cvt_pk_bf16_f32 v44, v30, v31
    v_lshlrev_b32 v30, 16, v44
    v_and_b32 v31, 0xffff0000, v44
    v_cvt_pk_bf16_f32 v44, v32, v33
    v_lshlrev_b32 v32, 16, v44
    v_and_b32 v33, 0xffff0000, v44
    v_cvt_pk_bf16_f32 v44, v34, v35
    v_lshlrev_b32 v34, 16, v44
    v_and_b32 v35, 0xffff0000, v44
    v_cvt_pk_bf16_f32 v44, v36, v37
    v_lshlrev_b32 v36, 16, v44
    v_and_b32 v37, 0xffff0000, v44
    v_cvt_pk_bf16_f32 v44, v38, v39
    v_lshlrev_b32 v38, 16, v44
    v_and_b32 v39, 0xffff0000, v44
    v_cvt_pk_bf16_f32 v10, v30, v31
    buffer_store_dword v10, v1, s[12:15], 0 offen offset:0
    v_cvt_pk_bf16_f32 v11, v32, v33
    buffer_store_dword v11, v1, s[12:15], 0 offen offset:256
    v_cvt_pk_bf16_f32 v12, v34, v35
    buffer_store_dword v12, v1, s[12:15], 0 offen offset:512
    v_cvt_pk_bf16_f32 v13, v36, v37
    buffer_store_dword v13, v1, s[12:15], 0 offen offset:768
    v_cvt_pk_bf16_f32 v14, v38, v39
    buffer_store_dword v14, v1, s[12:15], 0 offen offset:1024
lnx_kernel_done:
    s_endpgm
.globl g1_kernel
.p2align 8
.type g1_kernel,@function
g1_kernel:
    s_cmp_ge_u32 s2, 256
    s_cbranch_scc1 g1_kernel_done
    v_and_b32 v1, 63, v0
    v_and_b32 v2, 15, v0
    v_lshrrev_b32 v3, 4, v1
    v_lshrrev_b32 v4, 6, v0
    s_nop 0
    v_readfirstlane_b32 s23, v4
    s_load_dwordx2 s[4:5], s[0:1], 24
    s_load_dwordx2 s[6:7], s[0:1], 32
    s_load_dwordx2 s[24:25], s[0:1], 96
    s_and_b32 s20, s2, 15
    s_lshr_b32 s26, s2, 4
    s_and_b32 s21, s26, 7
    s_lshr_b32 s22, s26, 3
    s_waitcnt lgkmcnt(0)
    s_cmp_eq_u32 s22, 0
    s_cselect_b32 s4, s4, s6
    s_cselect_b32 s5, s5, s7
    s_mov_b32 s12, s4
    s_mov_b32 s13, s5
    s_mov_b32 s14, 0xc8000
    s_mov_b32 s15, 0x00020000
    s_mov_b32 s8, s24
    s_mov_b32 s9, s25
    s_mov_b32 s10, 0x280000
    s_mov_b32 s11, 0x00020000
    s_mul_i32 s26, s22, 0x280000
    s_add_u32 s26, s26, 0x400000
    s_add_u32 s16, s24, s26
    s_addc_u32 s17, s25, 0
    s_mov_b32 s18, 0x280000
    s_mov_b32 s19, 0x00020000
    s_lshl_b32 s26, s20, 7
    s_lshl_b32 s27, s23, 5
    s_add_u32 s26, s26, s27
    s_mul_i32 s27, s21, 80
    v_add_u32 v5, s27, v2
    s_mov_b32 s27, 4096
    v_mul_lo_u32 v8, v5, s27
    s_lshl_b32 s26, s26, 1
    v_add_u32 v8, s26, v8
    v_lshl_add_u32 v8, v3, 3, v8
    v_add_u32 v9, 32, v8
    s_mul_i32 s26, s23, 32
    s_add_u32 s26, s26, 0
    v_add_u32 v60, s26, v3
    v_and_b32 v61, 15, v60
    v_xor_b32 v61, v61, v2
    s_mul_i32 s27, s20, 128
    v_add_u32 v60, s27, v60
    s_mov_b32 s27, 1280
    v_mul_lo_u32 v60, v60, s27
    v_lshl_add_u32 v10, v61, 4, v60
    s_mul_i32 s26, s23, 32
    s_add_u32 s26, s26, 4
    v_add_u32 v60, s26, v3
    v_and_b32 v61, 15, v60
    v_xor_b32 v61, v61, v2
    s_mul_i32 s27, s20, 128
    v_add_u32 v60, s27, v60
    s_mov_b32 s27, 1280
    v_mul_lo_u32 v60, v60, s27
    v_lshl_add_u32 v11, v61, 4, v60
    s_mul_i32 s26, s23, 32
    s_add_u32 s26, s26, 8
    v_add_u32 v60, s26, v3
    v_and_b32 v61, 15, v60
    v_xor_b32 v61, v61, v2
    s_mul_i32 s27, s20, 128
    v_add_u32 v60, s27, v60
    s_mov_b32 s27, 1280
    v_mul_lo_u32 v60, v60, s27
    v_lshl_add_u32 v12, v61, 4, v60
    s_mul_i32 s26, s23, 32
    s_add_u32 s26, s26, 12
    v_add_u32 v60, s26, v3
    v_and_b32 v61, 15, v60
    v_xor_b32 v61, v61, v2
    s_mul_i32 s27, s20, 128
    v_add_u32 v60, s27, v60
    s_mov_b32 s27, 1280
    v_mul_lo_u32 v60, v60, s27
    v_lshl_add_u32 v13, v61, 4, v60
    s_mul_i32 s26, s23, 32
    s_add_u32 s26, s26, 16
    v_add_u32 v60, s26, v3
    v_and_b32 v61, 15, v60
    v_xor_b32 v61, v61, v2
    s_mul_i32 s27, s20, 128
    v_add_u32 v60, s27, v60
    s_mov_b32 s27, 1280
    v_mul_lo_u32 v60, v60, s27
    v_lshl_add_u32 v14, v61, 4, v60
    s_mul_i32 s26, s23, 32
    s_add_u32 s26, s26, 20
    v_add_u32 v60, s26, v3
    v_and_b32 v61, 15, v60
    v_xor_b32 v61, v61, v2
    s_mul_i32 s27, s20, 128
    v_add_u32 v60, s27, v60
    s_mov_b32 s27, 1280
    v_mul_lo_u32 v60, v60, s27
    v_lshl_add_u32 v15, v61, 4, v60
    s_mul_i32 s26, s23, 32
    s_add_u32 s26, s26, 24
    v_add_u32 v60, s26, v3
    v_and_b32 v61, 15, v60
    v_xor_b32 v61, v61, v2
    s_mul_i32 s27, s20, 128
    v_add_u32 v60, s27, v60
    s_mov_b32 s27, 1280
    v_mul_lo_u32 v60, v60, s27
    v_lshl_add_u32 v16, v61, 4, v60
    s_mul_i32 s26, s23, 32
    s_add_u32 s26, s26, 28
    v_add_u32 v60, s26, v3
    v_and_b32 v61, 15, v60
    v_xor_b32 v61, v61, v2
    s_mul_i32 s27, s20, 128
    v_add_u32 v60, s27, v60
    s_mov_b32 s27, 1280
    v_mul_lo_u32 v60, v60, s27
    v_lshl_add_u32 v17, v61, 4, v60
    s_mul_i32 s26, s23, 20
    s_add_u32 s26, s26, 0
    v_add_u32 v60, s26, v3
    v_and_b32 v61, 15, v60
    v_xor_b32 v61, v61, v2
    s_mul_i32 s27, s21, 80
    v_add_u32 v60, s27, v60
    s_mov_b32 s27, 1280
    v_mul_lo_u32 v60, v60, s27
    v_lshl_add_u32 v18, v61, 4, v60
    s_mul_i32 s26, s23, 20
    s_add_u32 s26, s26, 4
    v_add_u32 v60, s26, v3
    v_and_b32 v61, 15, v60
    v_xor_b32 v61, v61, v2
    s_mul_i32 s27, s21, 80
    v_add_u32 v60, s27, v60
    s_mov_b32 s27, 1280
    v_mul_lo_u32 v60, v60, s27
    v_lshl_add_u32 v19, v61, 4, v60
    s_mul_i32 s26, s23, 20
    s_add_u32 s26, s26, 8
    v_add_u32 v60, s26, v3
    v_and_b32 v61, 15, v60
    v_xor_b32 v61, v61, v2
    s_mul_i32 s27, s21, 80
    v_add_u32 v60, s27, v60
    s_mov_b32 s27, 1280
    v_mul_lo_u32 v60, v60, s27
    v_lshl_add_u32 v20, v61, 4, v60
    s_mul_i32 s26, s23, 20
    s_add_u32 s26, s26, 12
    v_add_u32 v60, s26, v3
    v_and_b32 v61, 15, v60
    v_xor_b32 v61, v61, v2
    s_mul_i32 s27, s21, 80
    v_add_u32 v60, s27, v60
    s_mov_b32 s27, 1280
    v_mul_lo_u32 v60, v60, s27
    v_lshl_add_u32 v21, v61, 4, v60
    s_mul_i32 s26, s23, 20
    s_add_u32 s26, s26, 16
    v_add_u32 v60, s26, v3
    v_and_b32 v61, 15, v60
    v_xor_b32 v61, v61, v2
    s_mul_i32 s27, s21, 80
    v_add_u32 v60, s27, v60
    s_mov_b32 s27, 1280
    v_mul_lo_u32 v60, v60, s27
    v_lshl_add_u32 v22, v61, 4, v60
    s_lshl_b32 s26, s23, 13
    v_lshlrev_b32 v60, 1, v3
    v_add_u32 v60, 0, v60
    v_xor_b32 v60, v60, v2
    v_lshlrev_b32 v60, 4, v60
    v_lshl_add_u32 v23, v2, 8, v60
    v_add_u32 v27, 0x10000, v23
    v_add_u32 v31, s26, v23
    v_add_u32 v35, 0x10000, v31
    v_lshlrev_b32 v60, 1, v3
    v_add_u32 v60, 1, v60
    v_xor_b32 v60, v60, v2
    v_lshlrev_b32 v60, 4, v60
    v_lshl_add_u32 v24, v2, 8, v60
    v_add_u32 v28, 0x10000, v24
    v_add_u32 v32, s26, v24
    v_add_u32 v36, 0x10000, v32
    v_lshlrev_b32 v60, 1, v3
    v_add_u32 v60, 8, v60
    v_xor_b32 v60, v60, v2
    v_lshlrev_b32 v60, 4, v60
    v_lshl_add_u32 v25, v2, 8, v60
    v_add_u32 v29, 0x10000, v25
    v_add_u32 v33, s26, v25
    v_add_u32 v37, 0x10000, v33
    v_lshlrev_b32 v60, 1, v3
    v_add_u32 v60, 9, v60
    v_xor_b32 v60, v60, v2
    v_lshlrev_b32 v60, 4, v60
    v_lshl_add_u32 v26, v2, 8, v60
    v_add_u32 v30, 0x10000, v26
    v_add_u32 v34, s26, v26
    v_add_u32 v38, 0x10000, v34
    s_mul_i32 s28, s23, 8192
    s_mul_i32 s30, s23, 5120
    s_add_u32 s30, s30, 32768
    s_mov_b32 s29, 0
    s_add_u32 m0, s28, 0
    s_nop 0
    buffer_load_dwordx4 v10, s[8:11], s29 offen lds
    s_add_u32 m0, s28, 1024
    s_nop 0
    buffer_load_dwordx4 v11, s[8:11], s29 offen lds
    s_add_u32 m0, s28, 2048
    s_nop 0
    buffer_load_dwordx4 v12, s[8:11], s29 offen lds
    s_add_u32 m0, s28, 3072
    s_nop 0
    buffer_load_dwordx4 v13, s[8:11], s29 offen lds
    s_add_u32 m0, s28, 4096
    s_nop 0
    buffer_load_dwordx4 v14, s[8:11], s29 offen lds
    s_add_u32 m0, s28, 5120
    s_nop 0
    buffer_load_dwordx4 v15, s[8:11], s29 offen lds
    s_add_u32 m0, s28, 6144
    s_nop 0
    buffer_load_dwordx4 v16, s[8:11], s29 offen lds
    s_add_u32 m0, s28, 7168
    s_nop 0
    buffer_load_dwordx4 v17, s[8:11], s29 offen lds
    s_add_u32 m0, s30, 0
    s_nop 0
    buffer_load_dwordx4 v18, s[12:15], s29 offen lds
    s_add_u32 m0, s30, 1024
    s_nop 0
    buffer_load_dwordx4 v19, s[12:15], s29 offen lds
    s_add_u32 m0, s30, 2048
    s_nop 0
    buffer_load_dwordx4 v20, s[12:15], s29 offen lds
    s_add_u32 m0, s30, 3072
    s_nop 0
    buffer_load_dwordx4 v21, s[12:15], s29 offen lds
    s_add_u32 m0, s30, 4096
    s_nop 0
    buffer_load_dwordx4 v22, s[12:15], s29 offen lds
    s_add_u32 s29, s29, 256
    s_add_u32 m0, s28, 53248
    s_nop 0
    buffer_load_dwordx4 v10, s[8:11], s29 offen lds
    s_add_u32 m0, s28, 54272
    s_nop 0
    buffer_load_dwordx4 v11, s[8:11], s29 offen lds
    s_add_u32 m0, s28, 55296
    s_nop 0
    buffer_load_dwordx4 v12, s[8:11], s29 offen lds
    s_add_u32 m0, s28, 56320
    s_nop 0
    buffer_load_dwordx4 v13, s[8:11], s29 offen lds
    s_add_u32 m0, s28, 57344
    s_nop 0
    buffer_load_dwordx4 v14, s[8:11], s29 offen lds
    s_add_u32 m0, s28, 58368
    s_nop 0
    buffer_load_dwordx4 v15, s[8:11], s29 offen lds
    s_add_u32 m0, s28, 59392
    s_nop 0
    buffer_load_dwordx4 v16, s[8:11], s29 offen lds
    s_add_u32 m0, s28, 60416
    s_nop 0
    buffer_load_dwordx4 v17, s[8:11], s29 offen lds
    s_add_u32 m0, s30, 53248
    s_nop 0
    buffer_load_dwordx4 v18, s[12:15], s29 offen lds
    s_add_u32 m0, s30, 54272
    s_nop 0
    buffer_load_dwordx4 v19, s[12:15], s29 offen lds
    s_add_u32 m0, s30, 55296
    s_nop 0
    buffer_load_dwordx4 v20, s[12:15], s29 offen lds
    s_add_u32 m0, s30, 56320
    s_nop 0
    buffer_load_dwordx4 v21, s[12:15], s29 offen lds
    s_add_u32 m0, s30, 57344
    s_nop 0
    buffer_load_dwordx4 v22, s[12:15], s29 offen lds
    s_add_u32 s29, s29, 256
    s_mov_b32 s31, 5
    v_mov_b32 v40, 0
    v_mov_b32 v41, 0
    v_mov_b32 v42, 0
    v_mov_b32 v43, 0
    v_mov_b32 v44, 0
    v_mov_b32 v45, 0
    v_mov_b32 v46, 0
    v_mov_b32 v47, 0
    v_mov_b32 v48, 0
    v_mov_b32 v49, 0
    v_mov_b32 v50, 0
    v_mov_b32 v51, 0
    v_mov_b32 v52, 0
    v_mov_b32 v53, 0
    v_mov_b32 v54, 0
    v_mov_b32 v55, 0
    v_mov_b32 v56, 0
    v_mov_b32 v57, 0
    v_mov_b32 v58, 0
    v_mov_b32 v59, 0
    v_mov_b32 v60, 0
    v_mov_b32 v61, 0
    v_mov_b32 v62, 0
    v_mov_b32 v63, 0
    v_mov_b32 v64, 0
    v_mov_b32 v65, 0
    v_mov_b32 v66, 0
    v_mov_b32 v67, 0
    v_mov_b32 v68, 0
    v_mov_b32 v69, 0
    v_mov_b32 v70, 0
    v_mov_b32 v71, 0
    v_mov_b32 v72, 0
    v_mov_b32 v73, 0
    v_mov_b32 v74, 0
    v_mov_b32 v75, 0
    v_mov_b32 v76, 0
    v_mov_b32 v77, 0
    v_mov_b32 v78, 0
    v_mov_b32 v79, 0
    s_waitcnt vmcnt(13)
    s_barrier
    ds_read_b128 v[120:123], v31 offset:0
    ds_read_b128 v[124:127], v31 offset:4096
    ds_read_b128 v[80:83], v23 offset:32768
    ds_read_b128 v[84:87], v23 offset:36864
    ds_read_b128 v[88:91], v23 offset:40960
    ds_read_b128 v[92:95], v23 offset:45056
    ds_read_b128 v[96:99], v23 offset:49152
g1_kernel_loop:
    s_add_u32 m0, s28, 106496
    s_nop 0
    buffer_load_dwordx4 v10, s[8:11], s29 offen lds
    s_add_u32 m0, s28, 107520
    s_nop 0
    buffer_load_dwordx4 v11, s[8:11], s29 offen lds
    s_add_u32 m0, s28, 108544
    s_nop 0
    buffer_load_dwordx4 v12, s[8:11], s29 offen lds
    s_add_u32 m0, s28, 109568
    s_nop 0
    buffer_load_dwordx4 v13, s[8:11], s29 offen lds
    s_add_u32 m0, s28, 110592
    s_nop 0
    buffer_load_dwordx4 v14, s[8:11], s29 offen lds
    s_add_u32 m0, s28, 111616
    s_nop 0
    buffer_load_dwordx4 v15, s[8:11], s29 offen lds
    s_add_u32 m0, s28, 112640
    s_nop 0
    buffer_load_dwordx4 v16, s[8:11], s29 offen lds
    s_add_u32 m0, s28, 113664
    s_nop 0
    buffer_load_dwordx4 v17, s[8:11], s29 offen lds
    s_add_u32 m0, s30, 106496
    s_nop 0
    buffer_load_dwordx4 v18, s[12:15], s29 offen lds
    s_add_u32 m0, s30, 107520
    s_nop 0
    buffer_load_dwordx4 v19, s[12:15], s29 offen lds
    s_add_u32 m0, s30, 108544
    s_nop 0
    buffer_load_dwordx4 v20, s[12:15], s29 offen lds
    s_add_u32 m0, s30, 109568
    s_nop 0
    buffer_load_dwordx4 v21, s[12:15], s29 offen lds
    s_add_u32 m0, s30, 110592
    s_nop 0
    buffer_load_dwordx4 v22, s[12:15], s29 offen lds
    s_add_u32 s29, s29, 256
    ds_read_b128 v[128:131], v32 offset:0
    ds_read_b128 v[132:135], v32 offset:4096
    ds_read_b128 v[100:103], v24 offset:32768
    ds_read_b128 v[104:107], v24 offset:36864
    ds_read_b128 v[108:111], v24 offset:40960
    ds_read_b128 v[112:115], v24 offset:45056
    ds_read_b128 v[116:119], v24 offset:49152
    s_waitcnt lgkmcnt(7)
    v_mfma_f32_16x16x32_bf16 v[40:43], v[120:123], v[80:83], v[40:43]
    v_mfma_f32_16x16x32_bf16 v[44:47], v[120:123], v[84:87], v[44:47]
    v_mfma_f32_16x16x32_bf16 v[48:51], v[120:123], v[88:91], v[48:51]
    v_mfma_f32_16x16x32_bf16 v[52:55], v[120:123], v[92:95], v[52:55]
    v_mfma_f32_16x16x32_bf16 v[56:59], v[120:123], v[96:99], v[56:59]
    v_mfma_f32_16x16x32_bf16 v[60:63], v[124:127], v[80:83], v[60:63]
    v_mfma_f32_16x16x32_bf16 v[64:67], v[124:127], v[84:87], v[64:67]
    v_mfma_f32_16x16x32_bf16 v[68:71], v[124:127], v[88:91], v[68:71]
    v_mfma_f32_16x16x32_bf16 v[72:75], v[124:127], v[92:95], v[72:75]
    v_mfma_f32_16x16x32_bf16 v[76:79], v[124:127], v[96:99], v[76:79]
    ds_read_b128 v[120:123], v33 offset:0
    ds_read_b128 v[124:127], v33 offset:4096
    ds_read_b128 v[80:83], v25 offset:32768
    ds_read_b128 v[84:87], v25 offset:36864
    ds_read_b128 v[88:91], v25 offset:40960
    ds_read_b128 v[92:95], v25 offset:45056
    ds_read_b128 v[96:99], v25 offset:49152
    s_waitcnt lgkmcnt(7)
    v_mfma_f32_16x16x32_bf16 v[40:43], v[128:131], v[100:103], v[40:43]
    v_mfma_f32_16x16x32_bf16 v[44:47], v[128:131], v[104:107], v[44:47]
    v_mfma_f32_16x16x32_bf16 v[48:51], v[128:131], v[108:111], v[48:51]
    v_mfma_f32_16x16x32_bf16 v[52:55], v[128:131], v[112:115], v[52:55]
    v_mfma_f32_16x16x32_bf16 v[56:59], v[128:131], v[116:119], v[56:59]
    v_mfma_f32_16x16x32_bf16 v[60:63], v[132:135], v[100:103], v[60:63]
    v_mfma_f32_16x16x32_bf16 v[64:67], v[132:135], v[104:107], v[64:67]
    v_mfma_f32_16x16x32_bf16 v[68:71], v[132:135], v[108:111], v[68:71]
    v_mfma_f32_16x16x32_bf16 v[72:75], v[132:135], v[112:115], v[72:75]
    v_mfma_f32_16x16x32_bf16 v[76:79], v[132:135], v[116:119], v[76:79]
    ds_read_b128 v[128:131], v34 offset:0
    ds_read_b128 v[132:135], v34 offset:4096
    ds_read_b128 v[100:103], v26 offset:32768
    ds_read_b128 v[104:107], v26 offset:36864
    ds_read_b128 v[108:111], v26 offset:40960
    ds_read_b128 v[112:115], v26 offset:45056
    ds_read_b128 v[116:119], v26 offset:49152
    s_waitcnt lgkmcnt(7)
    v_mfma_f32_16x16x32_bf16 v[40:43], v[120:123], v[80:83], v[40:43]
    v_mfma_f32_16x16x32_bf16 v[44:47], v[120:123], v[84:87], v[44:47]
    v_mfma_f32_16x16x32_bf16 v[48:51], v[120:123], v[88:91], v[48:51]
    v_mfma_f32_16x16x32_bf16 v[52:55], v[120:123], v[92:95], v[52:55]
    v_mfma_f32_16x16x32_bf16 v[56:59], v[120:123], v[96:99], v[56:59]
    v_mfma_f32_16x16x32_bf16 v[60:63], v[124:127], v[80:83], v[60:63]
    v_mfma_f32_16x16x32_bf16 v[64:67], v[124:127], v[84:87], v[64:67]
    v_mfma_f32_16x16x32_bf16 v[68:71], v[124:127], v[88:91], v[68:71]
    v_mfma_f32_16x16x32_bf16 v[72:75], v[124:127], v[92:95], v[72:75]
    v_mfma_f32_16x16x32_bf16 v[76:79], v[124:127], v[96:99], v[76:79]
    s_waitcnt vmcnt(13) lgkmcnt(0)
    s_barrier
    ds_read_b128 v[120:123], v31 offset:53248
    ds_read_b128 v[124:127], v31 offset:57344
    ds_read_b128 v[80:83], v27 offset:20480
    ds_read_b128 v[84:87], v27 offset:24576
    ds_read_b128 v[88:91], v27 offset:28672
    ds_read_b128 v[92:95], v27 offset:32768
    ds_read_b128 v[96:99], v27 offset:36864
    v_mfma_f32_16x16x32_bf16 v[40:43], v[128:131], v[100:103], v[40:43]
    v_mfma_f32_16x16x32_bf16 v[44:47], v[128:131], v[104:107], v[44:47]
    v_mfma_f32_16x16x32_bf16 v[48:51], v[128:131], v[108:111], v[48:51]
    v_mfma_f32_16x16x32_bf16 v[52:55], v[128:131], v[112:115], v[52:55]
    v_mfma_f32_16x16x32_bf16 v[56:59], v[128:131], v[116:119], v[56:59]
    v_mfma_f32_16x16x32_bf16 v[60:63], v[132:135], v[100:103], v[60:63]
    v_mfma_f32_16x16x32_bf16 v[64:67], v[132:135], v[104:107], v[64:67]
    v_mfma_f32_16x16x32_bf16 v[68:71], v[132:135], v[108:111], v[68:71]
    v_mfma_f32_16x16x32_bf16 v[72:75], v[132:135], v[112:115], v[72:75]
    v_mfma_f32_16x16x32_bf16 v[76:79], v[132:135], v[116:119], v[76:79]
    s_sub_u32 s31, s31, 1
    s_cmp_eq_u32 s31, 0
    s_cbranch_scc1 g1_kernel_exit
    s_add_u32 m0, s28, 0
    s_nop 0
    buffer_load_dwordx4 v10, s[8:11], s29 offen lds
    s_add_u32 m0, s28, 1024
    s_nop 0
    buffer_load_dwordx4 v11, s[8:11], s29 offen lds
    s_add_u32 m0, s28, 2048
    s_nop 0
    buffer_load_dwordx4 v12, s[8:11], s29 offen lds
    s_add_u32 m0, s28, 3072
    s_nop 0
    buffer_load_dwordx4 v13, s[8:11], s29 offen lds
    s_add_u32 m0, s28, 4096
    s_nop 0
    buffer_load_dwordx4 v14, s[8:11], s29 offen lds
    s_add_u32 m0, s28, 5120
    s_nop 0
    buffer_load_dwordx4 v15, s[8:11], s29 offen lds
    s_add_u32 m0, s28, 6144
    s_nop 0
    buffer_load_dwordx4 v16, s[8:11], s29 offen lds
    s_add_u32 m0, s28, 7168
    s_nop 0
    buffer_load_dwordx4 v17, s[8:11], s29 offen lds
    s_add_u32 m0, s30, 0
    s_nop 0
    buffer_load_dwordx4 v18, s[12:15], s29 offen lds
    s_add_u32 m0, s30, 1024
    s_nop 0
    buffer_load_dwordx4 v19, s[12:15], s29 offen lds
    s_add_u32 m0, s30, 2048
    s_nop 0
    buffer_load_dwordx4 v20, s[12:15], s29 offen lds
    s_add_u32 m0, s30, 3072
    s_nop 0
    buffer_load_dwordx4 v21, s[12:15], s29 offen lds
    s_add_u32 m0, s30, 4096
    s_nop 0
    buffer_load_dwordx4 v22, s[12:15], s29 offen lds
    s_add_u32 s29, s29, 256
    ds_read_b128 v[128:131], v32 offset:53248
    ds_read_b128 v[132:135], v32 offset:57344
    ds_read_b128 v[100:103], v28 offset:20480
    ds_read_b128 v[104:107], v28 offset:24576
    ds_read_b128 v[108:111], v28 offset:28672
    ds_read_b128 v[112:115], v28 offset:32768
    ds_read_b128 v[116:119], v28 offset:36864
    s_waitcnt lgkmcnt(7)
    v_mfma_f32_16x16x32_bf16 v[40:43], v[120:123], v[80:83], v[40:43]
    v_mfma_f32_16x16x32_bf16 v[44:47], v[120:123], v[84:87], v[44:47]
    v_mfma_f32_16x16x32_bf16 v[48:51], v[120:123], v[88:91], v[48:51]
    v_mfma_f32_16x16x32_bf16 v[52:55], v[120:123], v[92:95], v[52:55]
    v_mfma_f32_16x16x32_bf16 v[56:59], v[120:123], v[96:99], v[56:59]
    v_mfma_f32_16x16x32_bf16 v[60:63], v[124:127], v[80:83], v[60:63]
    v_mfma_f32_16x16x32_bf16 v[64:67], v[124:127], v[84:87], v[64:67]
    v_mfma_f32_16x16x32_bf16 v[68:71], v[124:127], v[88:91], v[68:71]
    v_mfma_f32_16x16x32_bf16 v[72:75], v[124:127], v[92:95], v[72:75]
    v_mfma_f32_16x16x32_bf16 v[76:79], v[124:127], v[96:99], v[76:79]
    ds_read_b128 v[120:123], v33 offset:53248
    ds_read_b128 v[124:127], v33 offset:57344
    ds_read_b128 v[80:83], v29 offset:20480
    ds_read_b128 v[84:87], v29 offset:24576
    ds_read_b128 v[88:91], v29 offset:28672
    ds_read_b128 v[92:95], v29 offset:32768
    ds_read_b128 v[96:99], v29 offset:36864
    s_waitcnt lgkmcnt(7)
    v_mfma_f32_16x16x32_bf16 v[40:43], v[128:131], v[100:103], v[40:43]
    v_mfma_f32_16x16x32_bf16 v[44:47], v[128:131], v[104:107], v[44:47]
    v_mfma_f32_16x16x32_bf16 v[48:51], v[128:131], v[108:111], v[48:51]
    v_mfma_f32_16x16x32_bf16 v[52:55], v[128:131], v[112:115], v[52:55]
    v_mfma_f32_16x16x32_bf16 v[56:59], v[128:131], v[116:119], v[56:59]
    v_mfma_f32_16x16x32_bf16 v[60:63], v[132:135], v[100:103], v[60:63]
    v_mfma_f32_16x16x32_bf16 v[64:67], v[132:135], v[104:107], v[64:67]
    v_mfma_f32_16x16x32_bf16 v[68:71], v[132:135], v[108:111], v[68:71]
    v_mfma_f32_16x16x32_bf16 v[72:75], v[132:135], v[112:115], v[72:75]
    v_mfma_f32_16x16x32_bf16 v[76:79], v[132:135], v[116:119], v[76:79]
    ds_read_b128 v[128:131], v34 offset:53248
    ds_read_b128 v[132:135], v34 offset:57344
    ds_read_b128 v[100:103], v30 offset:20480
    ds_read_b128 v[104:107], v30 offset:24576
    ds_read_b128 v[108:111], v30 offset:28672
    ds_read_b128 v[112:115], v30 offset:32768
    ds_read_b128 v[116:119], v30 offset:36864
    s_waitcnt lgkmcnt(7)
    v_mfma_f32_16x16x32_bf16 v[40:43], v[120:123], v[80:83], v[40:43]
    v_mfma_f32_16x16x32_bf16 v[44:47], v[120:123], v[84:87], v[44:47]
    v_mfma_f32_16x16x32_bf16 v[48:51], v[120:123], v[88:91], v[48:51]
    v_mfma_f32_16x16x32_bf16 v[52:55], v[120:123], v[92:95], v[52:55]
    v_mfma_f32_16x16x32_bf16 v[56:59], v[120:123], v[96:99], v[56:59]
    v_mfma_f32_16x16x32_bf16 v[60:63], v[124:127], v[80:83], v[60:63]
    v_mfma_f32_16x16x32_bf16 v[64:67], v[124:127], v[84:87], v[64:67]
    v_mfma_f32_16x16x32_bf16 v[68:71], v[124:127], v[88:91], v[68:71]
    v_mfma_f32_16x16x32_bf16 v[72:75], v[124:127], v[92:95], v[72:75]
    v_mfma_f32_16x16x32_bf16 v[76:79], v[124:127], v[96:99], v[76:79]
    s_waitcnt vmcnt(13) lgkmcnt(0)
    s_barrier
    ds_read_b128 v[120:123], v35 offset:40960
    ds_read_b128 v[124:127], v35 offset:45056
    v_add_u32 v6, 0x10000, v27
    ds_read_b128 v[80:83], v6 offset:8192
    v_add_u32 v6, 0x10000, v27
    ds_read_b128 v[84:87], v6 offset:12288
    v_add_u32 v6, 0x10000, v27
    ds_read_b128 v[88:91], v6 offset:16384
    v_add_u32 v6, 0x10000, v27
    ds_read_b128 v[92:95], v6 offset:20480
    v_add_u32 v6, 0x10000, v27
    ds_read_b128 v[96:99], v6 offset:24576
    v_mfma_f32_16x16x32_bf16 v[40:43], v[128:131], v[100:103], v[40:43]
    v_mfma_f32_16x16x32_bf16 v[44:47], v[128:131], v[104:107], v[44:47]
    v_mfma_f32_16x16x32_bf16 v[48:51], v[128:131], v[108:111], v[48:51]
    v_mfma_f32_16x16x32_bf16 v[52:55], v[128:131], v[112:115], v[52:55]
    v_mfma_f32_16x16x32_bf16 v[56:59], v[128:131], v[116:119], v[56:59]
    v_mfma_f32_16x16x32_bf16 v[60:63], v[132:135], v[100:103], v[60:63]
    v_mfma_f32_16x16x32_bf16 v[64:67], v[132:135], v[104:107], v[64:67]
    v_mfma_f32_16x16x32_bf16 v[68:71], v[132:135], v[108:111], v[68:71]
    v_mfma_f32_16x16x32_bf16 v[72:75], v[132:135], v[112:115], v[72:75]
    v_mfma_f32_16x16x32_bf16 v[76:79], v[132:135], v[116:119], v[76:79]
    s_sub_u32 s31, s31, 1
    s_cmp_eq_u32 s31, 0
    s_cbranch_scc1 g1_kernel_exit
    s_add_u32 m0, s28, 53248
    s_nop 0
    buffer_load_dwordx4 v10, s[8:11], s29 offen lds
    s_add_u32 m0, s28, 54272
    s_nop 0
    buffer_load_dwordx4 v11, s[8:11], s29 offen lds
    s_add_u32 m0, s28, 55296
    s_nop 0
    buffer_load_dwordx4 v12, s[8:11], s29 offen lds
    s_add_u32 m0, s28, 56320
    s_nop 0
    buffer_load_dwordx4 v13, s[8:11], s29 offen lds
    s_add_u32 m0, s28, 57344
    s_nop 0
    buffer_load_dwordx4 v14, s[8:11], s29 offen lds
    s_add_u32 m0, s28, 58368
    s_nop 0
    buffer_load_dwordx4 v15, s[8:11], s29 offen lds
    s_add_u32 m0, s28, 59392
    s_nop 0
    buffer_load_dwordx4 v16, s[8:11], s29 offen lds
    s_add_u32 m0, s28, 60416
    s_nop 0
    buffer_load_dwordx4 v17, s[8:11], s29 offen lds
    s_add_u32 m0, s30, 53248
    s_nop 0
    buffer_load_dwordx4 v18, s[12:15], s29 offen lds
    s_add_u32 m0, s30, 54272
    s_nop 0
    buffer_load_dwordx4 v19, s[12:15], s29 offen lds
    s_add_u32 m0, s30, 55296
    s_nop 0
    buffer_load_dwordx4 v20, s[12:15], s29 offen lds
    s_add_u32 m0, s30, 56320
    s_nop 0
    buffer_load_dwordx4 v21, s[12:15], s29 offen lds
    s_add_u32 m0, s30, 57344
    s_nop 0
    buffer_load_dwordx4 v22, s[12:15], s29 offen lds
    s_add_u32 s29, s29, 256
    ds_read_b128 v[128:131], v36 offset:40960
    ds_read_b128 v[132:135], v36 offset:45056
    v_add_u32 v6, 0x10000, v28
    ds_read_b128 v[100:103], v6 offset:8192
    v_add_u32 v6, 0x10000, v28
    ds_read_b128 v[104:107], v6 offset:12288
    v_add_u32 v6, 0x10000, v28
    ds_read_b128 v[108:111], v6 offset:16384
    v_add_u32 v6, 0x10000, v28
    ds_read_b128 v[112:115], v6 offset:20480
    v_add_u32 v6, 0x10000, v28
    ds_read_b128 v[116:119], v6 offset:24576
    s_waitcnt lgkmcnt(7)
    v_mfma_f32_16x16x32_bf16 v[40:43], v[120:123], v[80:83], v[40:43]
    v_mfma_f32_16x16x32_bf16 v[44:47], v[120:123], v[84:87], v[44:47]
    v_mfma_f32_16x16x32_bf16 v[48:51], v[120:123], v[88:91], v[48:51]
    v_mfma_f32_16x16x32_bf16 v[52:55], v[120:123], v[92:95], v[52:55]
    v_mfma_f32_16x16x32_bf16 v[56:59], v[120:123], v[96:99], v[56:59]
    v_mfma_f32_16x16x32_bf16 v[60:63], v[124:127], v[80:83], v[60:63]
    v_mfma_f32_16x16x32_bf16 v[64:67], v[124:127], v[84:87], v[64:67]
    v_mfma_f32_16x16x32_bf16 v[68:71], v[124:127], v[88:91], v[68:71]
    v_mfma_f32_16x16x32_bf16 v[72:75], v[124:127], v[92:95], v[72:75]
    v_mfma_f32_16x16x32_bf16 v[76:79], v[124:127], v[96:99], v[76:79]
    ds_read_b128 v[120:123], v37 offset:40960
    ds_read_b128 v[124:127], v37 offset:45056
    v_add_u32 v6, 0x10000, v29
    ds_read_b128 v[80:83], v6 offset:8192
    v_add_u32 v6, 0x10000, v29
    ds_read_b128 v[84:87], v6 offset:12288
    v_add_u32 v6, 0x10000, v29
    ds_read_b128 v[88:91], v6 offset:16384
    v_add_u32 v6, 0x10000, v29
    ds_read_b128 v[92:95], v6 offset:20480
    v_add_u32 v6, 0x10000, v29
    ds_read_b128 v[96:99], v6 offset:24576
    s_waitcnt lgkmcnt(7)
    v_mfma_f32_16x16x32_bf16 v[40:43], v[128:131], v[100:103], v[40:43]
    v_mfma_f32_16x16x32_bf16 v[44:47], v[128:131], v[104:107], v[44:47]
    v_mfma_f32_16x16x32_bf16 v[48:51], v[128:131], v[108:111], v[48:51]
    v_mfma_f32_16x16x32_bf16 v[52:55], v[128:131], v[112:115], v[52:55]
    v_mfma_f32_16x16x32_bf16 v[56:59], v[128:131], v[116:119], v[56:59]
    v_mfma_f32_16x16x32_bf16 v[60:63], v[132:135], v[100:103], v[60:63]
    v_mfma_f32_16x16x32_bf16 v[64:67], v[132:135], v[104:107], v[64:67]
    v_mfma_f32_16x16x32_bf16 v[68:71], v[132:135], v[108:111], v[68:71]
    v_mfma_f32_16x16x32_bf16 v[72:75], v[132:135], v[112:115], v[72:75]
    v_mfma_f32_16x16x32_bf16 v[76:79], v[132:135], v[116:119], v[76:79]
    ds_read_b128 v[128:131], v38 offset:40960
    ds_read_b128 v[132:135], v38 offset:45056
    v_add_u32 v6, 0x10000, v30
    ds_read_b128 v[100:103], v6 offset:8192
    v_add_u32 v6, 0x10000, v30
    ds_read_b128 v[104:107], v6 offset:12288
    v_add_u32 v6, 0x10000, v30
    ds_read_b128 v[108:111], v6 offset:16384
    v_add_u32 v6, 0x10000, v30
    ds_read_b128 v[112:115], v6 offset:20480
    v_add_u32 v6, 0x10000, v30
    ds_read_b128 v[116:119], v6 offset:24576
    s_waitcnt lgkmcnt(7)
    v_mfma_f32_16x16x32_bf16 v[40:43], v[120:123], v[80:83], v[40:43]
    v_mfma_f32_16x16x32_bf16 v[44:47], v[120:123], v[84:87], v[44:47]
    v_mfma_f32_16x16x32_bf16 v[48:51], v[120:123], v[88:91], v[48:51]
    v_mfma_f32_16x16x32_bf16 v[52:55], v[120:123], v[92:95], v[52:55]
    v_mfma_f32_16x16x32_bf16 v[56:59], v[120:123], v[96:99], v[56:59]
    v_mfma_f32_16x16x32_bf16 v[60:63], v[124:127], v[80:83], v[60:63]
    v_mfma_f32_16x16x32_bf16 v[64:67], v[124:127], v[84:87], v[64:67]
    v_mfma_f32_16x16x32_bf16 v[68:71], v[124:127], v[88:91], v[68:71]
    v_mfma_f32_16x16x32_bf16 v[72:75], v[124:127], v[92:95], v[72:75]
    v_mfma_f32_16x16x32_bf16 v[76:79], v[124:127], v[96:99], v[76:79]
    s_waitcnt vmcnt(13) lgkmcnt(0)
    s_barrier
    ds_read_b128 v[120:123], v31 offset:0
    ds_read_b128 v[124:127], v31 offset:4096
    ds_read_b128 v[80:83], v23 offset:32768
    ds_read_b128 v[84:87], v23 offset:36864
    ds_read_b128 v[88:91], v23 offset:40960
    ds_read_b128 v[92:95], v23 offset:45056
    ds_read_b128 v[96:99], v23 offset:49152
    v_mfma_f32_16x16x32_bf16 v[40:43], v[128:131], v[100:103], v[40:43]
    v_mfma_f32_16x16x32_bf16 v[44:47], v[128:131], v[104:107], v[44:47]
    v_mfma_f32_16x16x32_bf16 v[48:51], v[128:131], v[108:111], v[48:51]
    v_mfma_f32_16x16x32_bf16 v[52:55], v[128:131], v[112:115], v[52:55]
    v_mfma_f32_16x16x32_bf16 v[56:59], v[128:131], v[116:119], v[56:59]
    v_mfma_f32_16x16x32_bf16 v[60:63], v[132:135], v[100:103], v[60:63]
    v_mfma_f32_16x16x32_bf16 v[64:67], v[132:135], v[104:107], v[64:67]
    v_mfma_f32_16x16x32_bf16 v[68:71], v[132:135], v[108:111], v[68:71]
    v_mfma_f32_16x16x32_bf16 v[72:75], v[132:135], v[112:115], v[72:75]
    v_mfma_f32_16x16x32_bf16 v[76:79], v[132:135], v[116:119], v[76:79]
    s_sub_u32 s31, s31, 1
    s_cmp_eq_u32 s31, 0
    s_cbranch_scc0 g1_kernel_loop
g1_kernel_exit:
    s_waitcnt vmcnt(0) lgkmcnt(0)
    s_nop 7
    s_nop 1
    v_cvt_pk_bf16_f32 v40, v40, v41
    v_cvt_pk_bf16_f32 v41, v42, v43
    s_mov_b32 s26, 0
    buffer_store_dwordx2 v[40:41], v8, s[16:19], s26 offen
    v_cvt_pk_bf16_f32 v44, v44, v45
    v_cvt_pk_bf16_f32 v45, v46, v47
    s_mov_b32 s26, 65536
    buffer_store_dwordx2 v[44:45], v8, s[16:19], s26 offen
    v_cvt_pk_bf16_f32 v48, v48, v49
    v_cvt_pk_bf16_f32 v49, v50, v51
    s_mov_b32 s26, 131072
    buffer_store_dwordx2 v[48:49], v8, s[16:19], s26 offen
    v_cvt_pk_bf16_f32 v52, v52, v53
    v_cvt_pk_bf16_f32 v53, v54, v55
    s_mov_b32 s26, 196608
    buffer_store_dwordx2 v[52:53], v8, s[16:19], s26 offen
    v_cvt_pk_bf16_f32 v56, v56, v57
    v_cvt_pk_bf16_f32 v57, v58, v59
    s_mov_b32 s26, 262144
    buffer_store_dwordx2 v[56:57], v8, s[16:19], s26 offen
    v_cvt_pk_bf16_f32 v60, v60, v61
    v_cvt_pk_bf16_f32 v61, v62, v63
    s_mov_b32 s26, 0
    buffer_store_dwordx2 v[60:61], v9, s[16:19], s26 offen
    v_cvt_pk_bf16_f32 v64, v64, v65
    v_cvt_pk_bf16_f32 v65, v66, v67
    s_mov_b32 s26, 65536
    buffer_store_dwordx2 v[64:65], v9, s[16:19], s26 offen
    v_cvt_pk_bf16_f32 v68, v68, v69
    v_cvt_pk_bf16_f32 v69, v70, v71
    s_mov_b32 s26, 131072
    buffer_store_dwordx2 v[68:69], v9, s[16:19], s26 offen
    v_cvt_pk_bf16_f32 v72, v72, v73
    v_cvt_pk_bf16_f32 v73, v74, v75
    s_mov_b32 s26, 196608
    buffer_store_dwordx2 v[72:73], v9, s[16:19], s26 offen
    v_cvt_pk_bf16_f32 v76, v76, v77
    v_cvt_pk_bf16_f32 v77, v78, v79
    s_mov_b32 s26, 262144
    buffer_store_dwordx2 v[76:77], v9, s[16:19], s26 offen
g1_kernel_done:
    s_endpgm
.globl g2_kernel
.p2align 8
.type g2_kernel,@function
g2_kernel:
    s_cmp_ge_u32 s2, 256
    s_cbranch_scc1 g2_kernel_done
    s_load_dwordx2 s[4:5], s[0:1], 8
    s_load_dwordx2 s[6:7], s[0:1], 16
    s_load_dwordx2 s[24:25], s[0:1], 96
    v_and_b32 v1, 63, v0
    v_and_b32 v2, 15, v0
    v_lshrrev_b32 v3, 4, v1
    v_lshrrev_b32 v4, 6, v0
    s_nop 0
    v_readfirstlane_b32 s23, v4
    s_and_b32 s26, s2, 7
    s_lshr_b32 s27, s2, 3
    s_and_b32 s21, s27, 3
    s_lshr_b32 s27, s27, 2
    s_lshl_b32 s26, s26, 3
    s_add_u32 s26, s26, s27
    s_and_b32 s20, s26, 15
    s_lshr_b32 s33, s26, 4
    s_and_b32 s22, s33, 1
    s_lshr_b32 s32, s33, 1
    s_waitcnt lgkmcnt(0)
    s_cmp_eq_u32 s22, 0
    s_cselect_b32 s4, s4, s6
    s_cselect_b32 s5, s5, s7
    s_mov_b32 s8, s4
    s_mov_b32 s9, s5
    s_mov_b32 s10, 0x800000
    s_mov_b32 s11, 0x00020000
    s_mul_i32 s26, s22, 0x280000
    s_add_u32 s27, s26, 0x400000
    s_add_u32 s12, s24, s27
    s_addc_u32 s13, s25, 0
    s_mov_b32 s14, 0x280000
    s_mov_b32 s15, 0x00020000
    s_mul_i32 s26, s33, 0x500000
    s_add_u32 s27, s26, 0x4000000
    s_add_u32 s16, s24, s27
    s_addc_u32 s17, s25, 0
    s_mov_b32 s18, 0x500000
    s_mov_b32 s19, 0x00020000
    s_lshr_b32 s34, s23, 1
    s_and_b32 s35, s23, 1
    s_lshl_b32 s26, s20, 7
    s_lshl_b32 s27, s34, 6
    s_add_u32 s26, s26, s27
    v_add_u32 v5, s26, v2
    v_mul_u32_u24 v8, 2560, v5
    s_mul_i32 s26, s21, 640
    s_mul_i32 s27, s35, 320
    s_add_u32 s26, s26, s27
    v_add_u32 v8, s26, v8
    v_lshl_add_u32 v8, v3, 4, v8
    v_lshrrev_b32 v6, 3, v1
    v_and_b32 v7, 7, v1
    s_mul_i32 s26, s23, 32
    s_add_u32 s26, s26, 0
    v_add_u32 v60, s26, v6
    v_bfe_u32 v61, v60, 1, 3
    v_xor_b32 v61, v61, v7
    s_mul_i32 s27, s20, 128
    v_add_u32 v60, s27, v60
    v_lshlrev_b32 v60, 12, v60
    v_lshl_add_u32 v10, v61, 4, v60
    s_mul_i32 s26, s23, 32
    s_add_u32 s26, s26, 8
    v_add_u32 v60, s26, v6
    v_bfe_u32 v61, v60, 1, 3
    v_xor_b32 v61, v61, v7
    s_mul_i32 s27, s20, 128
    v_add_u32 v60, s27, v60
    v_lshlrev_b32 v60, 12, v60
    v_lshl_add_u32 v11, v61, 4, v60
    s_mul_i32 s26, s23, 32
    s_add_u32 s26, s26, 16
    v_add_u32 v60, s26, v6
    v_bfe_u32 v61, v60, 1, 3
    v_xor_b32 v61, v61, v7
    s_mul_i32 s27, s20, 128
    v_add_u32 v60, s27, v60
    v_lshlrev_b32 v60, 12, v60
    v_lshl_add_u32 v12, v61, 4, v60
    s_mul_i32 s26, s23, 32
    s_add_u32 s26, s26, 24
    v_add_u32 v60, s26, v6
    v_bfe_u32 v61, v60, 1, 3
    v_xor_b32 v61, v61, v7
    s_mul_i32 s27, s20, 128
    v_add_u32 v60, s27, v60
    v_lshlrev_b32 v60, 12, v60
    v_lshl_add_u32 v13, v61, 4, v60
    s_mul_i32 s26, s23, 40
    s_add_u32 s26, s26, 0
    v_add_u32 v60, s26, v6
    v_bfe_u32 v61, v60, 1, 3
    v_xor_b32 v61, v61, v7
    s_mul_i32 s27, s21, 160
    v_add_u32 v60, s27, v60
    v_lshlrev_b32 v60, 12, v60
    v_lshl_add_u32 v14, v61, 4, v60
    s_mul_i32 s26, s23, 40
    s_add_u32 s26, s26, 8
    v_add_u32 v60, s26, v6
    v_bfe_u32 v61, v60, 1, 3
    v_xor_b32 v61, v61, v7
    s_mul_i32 s27, s21, 160
    v_add_u32 v60, s27, v60
    v_lshlrev_b32 v60, 12, v60
    v_lshl_add_u32 v15, v61, 4, v60
    s_mul_i32 s26, s23, 40
    s_add_u32 s26, s26, 16
    v_add_u32 v60, s26, v6
    v_bfe_u32 v61, v60, 1, 3
    v_xor_b32 v61, v61, v7
    s_mul_i32 s27, s21, 160
    v_add_u32 v60, s27, v60
    v_lshlrev_b32 v60, 12, v60
    v_lshl_add_u32 v16, v61, 4, v60
    s_mul_i32 s26, s23, 40
    s_add_u32 s26, s26, 24
    v_add_u32 v60, s26, v6
    v_bfe_u32 v61, v60, 1, 3
    v_xor_b32 v61, v61, v7
    s_mul_i32 s27, s21, 160
    v_add_u32 v60, s27, v60
    v_lshlrev_b32 v60, 12, v60
    v_lshl_add_u32 v17, v61, 4, v60
    s_mul_i32 s26, s23, 40
    s_add_u32 s26, s26, 32
    v_add_u32 v60, s26, v6
    v_bfe_u32 v61, v60, 1, 3
    v_xor_b32 v61, v61, v7
    s_mul_i32 s27, s21, 160
    v_add_u32 v60, s27, v60
    v_lshlrev_b32 v60, 12, v60
    v_lshl_add_u32 v18, v61, 4, v60
    s_lshl_b32 s26, s34, 13
    s_mul_i32 s27, s35, 10240
    s_add_u32 s27, s27, 16384
    v_add_u32 v60, 0, v3
    v_bfe_u32 v61, v2, 1, 3
    v_xor_b32 v60, v60, v61
    v_lshlrev_b32 v60, 4, v60
    v_lshl_add_u32 v60, v2, 7, v60
    v_add_u32 v61, 0x0, v60
    v_add_u32 v19, s26, v61
    v_add_u32 v25, s27, v61
    v_add_u32 v61, 0x10000, v60
    v_add_u32 v20, s26, v61
    v_add_u32 v26, s27, v61
    v_add_u32 v61, 0x20000, v60
    v_add_u32 v21, s26, v61
    v_add_u32 v27, s27, v61
    v_add_u32 v60, 4, v3
    v_bfe_u32 v61, v2, 1, 3
    v_xor_b32 v60, v60, v61
    v_lshlrev_b32 v60, 4, v60
    v_lshl_add_u32 v60, v2, 7, v60
    v_add_u32 v61, 0x0, v60
    v_add_u32 v22, s26, v61
    v_add_u32 v28, s27, v61
    v_add_u32 v61, 0x10000, v60
    v_add_u32 v23, s26, v61
    v_add_u32 v29, s27, v61
    v_add_u32 v61, 0x20000, v60
    v_add_u32 v24, s26, v61
    v_add_u32 v30, s27, v61
    s_mul_i32 s28, s23, 4096
    s_mul_i32 s30, s23, 5120
    s_add_u32 s30, s30, 16384
    s_lshl_b32 s29, s32, 11
    s_add_u32 m0, s28, 0
    s_nop 0
    buffer_load_dwordx4 v10, s[8:11], s29 offen lds
    s_add_u32 m0, s28, 1024
    s_nop 0
    buffer_load_dwordx4 v11, s[8:11], s29 offen lds
    s_add_u32 m0, s28, 2048
    s_nop 0
    buffer_load_dwordx4 v12, s[8:11], s29 offen lds
    s_add_u32 m0, s28, 3072
    s_nop 0
    buffer_load_dwordx4 v13, s[8:11], s29 offen lds
    s_add_u32 m0, s30, 0
    s_nop 0
    buffer_load_dwordx4 v14, s[12:15], s29 offen lds
    s_add_u32 m0, s30, 1024
    s_nop 0
    buffer_load_dwordx4 v15, s[12:15], s29 offen lds
    s_add_u32 m0, s30, 2048
    s_nop 0
    buffer_load_dwordx4 v16, s[12:15], s29 offen lds
    s_add_u32 m0, s30, 3072
    s_nop 0
    buffer_load_dwordx4 v17, s[12:15], s29 offen lds
    s_add_u32 m0, s30, 4096
    s_nop 0
    buffer_load_dwordx4 v18, s[12:15], s29 offen lds
    s_add_u32 s29, s29, 128
    s_add_u32 m0, s28, 36864
    s_nop 0
    buffer_load_dwordx4 v10, s[8:11], s29 offen lds
    s_add_u32 m0, s28, 37888
    s_nop 0
    buffer_load_dwordx4 v11, s[8:11], s29 offen lds
    s_add_u32 m0, s28, 38912
    s_nop 0
    buffer_load_dwordx4 v12, s[8:11], s29 offen lds
    s_add_u32 m0, s28, 39936
    s_nop 0
    buffer_load_dwordx4 v13, s[8:11], s29 offen lds
    s_add_u32 m0, s30, 36864
    s_nop 0
    buffer_load_dwordx4 v14, s[12:15], s29 offen lds
    s_add_u32 m0, s30, 37888
    s_nop 0
    buffer_load_dwordx4 v15, s[12:15], s29 offen lds
    s_add_u32 m0, s30, 38912
    s_nop 0
    buffer_load_dwordx4 v16, s[12:15], s29 offen lds
    s_add_u32 m0, s30, 39936
    s_nop 0
    buffer_load_dwordx4 v17, s[12:15], s29 offen lds
    s_add_u32 m0, s30, 40960
    s_nop 0
    buffer_load_dwordx4 v18, s[12:15], s29 offen lds
    s_add_u32 s29, s29, 128
    s_add_u32 m0, s28, 73728
    s_nop 0
    buffer_load_dwordx4 v10, s[8:11], s29 offen lds
    s_add_u32 m0, s28, 74752
    s_nop 0
    buffer_load_dwordx4 v11, s[8:11], s29 offen lds
    s_add_u32 m0, s28, 75776
    s_nop 0
    buffer_load_dwordx4 v12, s[8:11], s29 offen lds
    s_add_u32 m0, s28, 76800
    s_nop 0
    buffer_load_dwordx4 v13, s[8:11], s29 offen lds
    s_add_u32 m0, s30, 73728
    s_nop 0
    buffer_load_dwordx4 v14, s[12:15], s29 offen lds
    s_add_u32 m0, s30, 74752
    s_nop 0
    buffer_load_dwordx4 v15, s[12:15], s29 offen lds
    s_add_u32 m0, s30, 75776
    s_nop 0
    buffer_load_dwordx4 v16, s[12:15], s29 offen lds
    s_add_u32 m0, s30, 76800
    s_nop 0
    buffer_load_dwordx4 v17, s[12:15], s29 offen lds
    s_add_u32 m0, s30, 77824
    s_nop 0
    buffer_load_dwordx4 v18, s[12:15], s29 offen lds
    s_add_u32 s29, s29, 128
    s_mov_b32 s31, 4
    v_mov_b32 v32, 0
    v_mov_b32 v33, 0
    v_mov_b32 v34, 0
    v_mov_b32 v35, 0
    v_mov_b32 v36, 0
    v_mov_b32 v37, 0
    v_mov_b32 v38, 0
    v_mov_b32 v39, 0
    v_mov_b32 v40, 0
    v_mov_b32 v41, 0
    v_mov_b32 v42, 0
    v_mov_b32 v43, 0
    v_mov_b32 v44, 0
    v_mov_b32 v45, 0
    v_mov_b32 v46, 0
    v_mov_b32 v47, 0
    v_mov_b32 v48, 0
    v_mov_b32 v49, 0
    v_mov_b32 v50, 0
    v_mov_b32 v51, 0
    v_mov_b32 v52, 0
    v_mov_b32 v53, 0
    v_mov_b32 v54, 0
    v_mov_b32 v55, 0
    v_mov_b32 v56, 0
    v_mov_b32 v57, 0
    v_mov_b32 v58, 0
    v_mov_b32 v59, 0
    v_mov_b32 v60, 0
    v_mov_b32 v61, 0
    v_mov_b32 v62, 0
    v_mov_b32 v63, 0
    v_mov_b32 v64, 0
    v_mov_b32 v65, 0
    v_mov_b32 v66, 0
    v_mov_b32 v67, 0
    v_mov_b32 v68, 0
    v_mov_b32 v69, 0
    v_mov_b32 v70, 0
    v_mov_b32 v71, 0
    v_mov_b32 v72, 0
    v_mov_b32 v73, 0
    v_mov_b32 v74, 0
    v_mov_b32 v75, 0
    v_mov_b32 v76, 0
    v_mov_b32 v77, 0
    v_mov_b32 v78, 0
    v_mov_b32 v79, 0
    v_mov_b32 v80, 0
    v_mov_b32 v81, 0
    v_mov_b32 v82, 0
    v_mov_b32 v83, 0
    v_mov_b32 v84, 0
    v_mov_b32 v85, 0
    v_mov_b32 v86, 0
    v_mov_b32 v87, 0
    v_mov_b32 v88, 0
    v_mov_b32 v89, 0
    v_mov_b32 v90, 0
    v_mov_b32 v91, 0
    v_mov_b32 v92, 0
    v_mov_b32 v93, 0
    v_mov_b32 v94, 0
    v_mov_b32 v95, 0
    v_mov_b32 v96, 0
    v_mov_b32 v97, 0
    v_mov_b32 v98, 0
    v_mov_b32 v99, 0
    v_mov_b32 v100, 0
    v_mov_b32 v101, 0
    v_mov_b32 v102, 0
    v_mov_b32 v103, 0
    v_mov_b32 v104, 0
    v_mov_b32 v105, 0
    v_mov_b32 v106, 0
    v_mov_b32 v107, 0
    v_mov_b32 v108, 0
    v_mov_b32 v109, 0
    v_mov_b32 v110, 0
    v_mov_b32 v111, 0
    s_waitcnt vmcnt(18)
    s_barrier
    ds_read_b128 v[152:155], v19 offset:0
    ds_read_b128 v[156:159], v19 offset:2048
    ds_read_b128 v[160:163], v19 offset:4096
    ds_read_b128 v[164:167], v19 offset:6144
    ds_read_b128 v[112:115], v25 offset:0
    ds_read_b128 v[116:119], v25 offset:2048
    ds_read_b128 v[120:123], v25 offset:4096
    ds_read_b128 v[124:127], v25 offset:6144
    ds_read_b128 v[128:131], v25 offset:8192
g2_kernel_loop:
    ds_read_b128 v[168:171], v22 offset:0
    ds_read_b128 v[172:175], v22 offset:2048
    ds_read_b128 v[176:179], v22 offset:4096
    ds_read_b128 v[180:183], v22 offset:6144
    ds_read_b128 v[132:135], v28 offset:0
    ds_read_b128 v[136:139], v28 offset:2048
    ds_read_b128 v[140:143], v28 offset:4096
    ds_read_b128 v[144:147], v28 offset:6144
    ds_read_b128 v[148:151], v28 offset:8192
    s_waitcnt lgkmcnt(9)
    v_mfma_f32_16x16x32_bf16 v[32:35], v[112:115], v[152:155], v[32:35]
    s_add_u32 m0, s28, 110592
    s_nop 0
    buffer_load_dwordx4 v10, s[8:11], s29 offen lds
    v_mfma_f32_16x16x32_bf16 v[36:39], v[116:119], v[152:155], v[36:39]
    v_mfma_f32_16x16x32_bf16 v[40:43], v[120:123], v[152:155], v[40:43]
    v_mfma_f32_16x16x32_bf16 v[44:47], v[124:127], v[152:155], v[44:47]
    v_mfma_f32_16x16x32_bf16 v[48:51], v[128:131], v[152:155], v[48:51]
    s_add_u32 m0, s28, 111616
    s_nop 0
    buffer_load_dwordx4 v11, s[8:11], s29 offen lds
    v_mfma_f32_16x16x32_bf16 v[52:55], v[112:115], v[156:159], v[52:55]
    v_mfma_f32_16x16x32_bf16 v[56:59], v[116:119], v[156:159], v[56:59]
    v_mfma_f32_16x16x32_bf16 v[60:63], v[120:123], v[156:159], v[60:63]
    v_mfma_f32_16x16x32_bf16 v[64:67], v[124:127], v[156:159], v[64:67]
    s_add_u32 m0, s28, 112640
    s_nop 0
    buffer_load_dwordx4 v12, s[8:11], s29 offen lds
    v_mfma_f32_16x16x32_bf16 v[68:71], v[128:131], v[156:159], v[68:71]
    v_mfma_f32_16x16x32_bf16 v[72:75], v[112:115], v[160:163], v[72:75]
    v_mfma_f32_16x16x32_bf16 v[76:79], v[116:119], v[160:163], v[76:79]
    v_mfma_f32_16x16x32_bf16 v[80:83], v[120:123], v[160:163], v[80:83]
    s_add_u32 m0, s28, 113664
    s_nop 0
    buffer_load_dwordx4 v13, s[8:11], s29 offen lds
    v_mfma_f32_16x16x32_bf16 v[84:87], v[124:127], v[160:163], v[84:87]
    v_mfma_f32_16x16x32_bf16 v[88:91], v[128:131], v[160:163], v[88:91]
    v_mfma_f32_16x16x32_bf16 v[92:95], v[112:115], v[164:167], v[92:95]
    v_mfma_f32_16x16x32_bf16 v[96:99], v[116:119], v[164:167], v[96:99]
    s_add_u32 m0, s30, 110592
    s_nop 0
    buffer_load_dwordx4 v14, s[12:15], s29 offen lds
    v_mfma_f32_16x16x32_bf16 v[100:103], v[120:123], v[164:167], v[100:103]
    v_mfma_f32_16x16x32_bf16 v[104:107], v[124:127], v[164:167], v[104:107]
    v_mfma_f32_16x16x32_bf16 v[108:111], v[128:131], v[164:167], v[108:111]
    s_add_u32 m0, s30, 111616
    s_nop 0
    buffer_load_dwordx4 v15, s[12:15], s29 offen lds
    s_add_u32 m0, s30, 112640
    s_nop 0
    buffer_load_dwordx4 v16, s[12:15], s29 offen lds
    s_add_u32 m0, s30, 113664
    s_nop 0
    buffer_load_dwordx4 v17, s[12:15], s29 offen lds
    s_add_u32 m0, s30, 114688
    s_nop 0
    buffer_load_dwordx4 v18, s[12:15], s29 offen lds
    s_add_u32 s29, s29, 128
    s_waitcnt vmcnt(18) lgkmcnt(0)
    s_barrier
    ds_read_b128 v[152:155], v19 offset:36864
    ds_read_b128 v[156:159], v19 offset:38912
    ds_read_b128 v[160:163], v19 offset:40960
    ds_read_b128 v[164:167], v19 offset:43008
    ds_read_b128 v[112:115], v25 offset:36864
    ds_read_b128 v[116:119], v25 offset:38912
    ds_read_b128 v[120:123], v25 offset:40960
    ds_read_b128 v[124:127], v25 offset:43008
    ds_read_b128 v[128:131], v25 offset:45056
    v_mfma_f32_16x16x32_bf16 v[32:35], v[132:135], v[168:171], v[32:35]
    v_mfma_f32_16x16x32_bf16 v[36:39], v[136:139], v[168:171], v[36:39]
    v_mfma_f32_16x16x32_bf16 v[40:43], v[140:143], v[168:171], v[40:43]
    v_mfma_f32_16x16x32_bf16 v[44:47], v[144:147], v[168:171], v[44:47]
    v_mfma_f32_16x16x32_bf16 v[48:51], v[148:151], v[168:171], v[48:51]
    v_mfma_f32_16x16x32_bf16 v[52:55], v[132:135], v[172:175], v[52:55]
    v_mfma_f32_16x16x32_bf16 v[56:59], v[136:139], v[172:175], v[56:59]
    v_mfma_f32_16x16x32_bf16 v[60:63], v[140:143], v[172:175], v[60:63]
    v_mfma_f32_16x16x32_bf16 v[64:67], v[144:147], v[172:175], v[64:67]
    v_mfma_f32_16x16x32_bf16 v[68:71], v[148:151], v[172:175], v[68:71]
    v_mfma_f32_16x16x32_bf16 v[72:75], v[132:135], v[176:179], v[72:75]
    v_mfma_f32_16x16x32_bf16 v[76:79], v[136:139], v[176:179], v[76:79]
    v_mfma_f32_16x16x32_bf16 v[80:83], v[140:143], v[176:179], v[80:83]
    v_mfma_f32_16x16x32_bf16 v[84:87], v[144:147], v[176:179], v[84:87]
    v_mfma_f32_16x16x32_bf16 v[88:91], v[148:151], v[176:179], v[88:91]
    v_mfma_f32_16x16x32_bf16 v[92:95], v[132:135], v[180:183], v[92:95]
    v_mfma_f32_16x16x32_bf16 v[96:99], v[136:139], v[180:183], v[96:99]
    v_mfma_f32_16x16x32_bf16 v[100:103], v[140:143], v[180:183], v[100:103]
    v_mfma_f32_16x16x32_bf16 v[104:107], v[144:147], v[180:183], v[104:107]
    v_mfma_f32_16x16x32_bf16 v[108:111], v[148:151], v[180:183], v[108:111]
    ds_read_b128 v[168:171], v22 offset:36864
    ds_read_b128 v[172:175], v22 offset:38912
    ds_read_b128 v[176:179], v22 offset:40960
    ds_read_b128 v[180:183], v22 offset:43008
    ds_read_b128 v[132:135], v28 offset:36864
    ds_read_b128 v[136:139], v28 offset:38912
    ds_read_b128 v[140:143], v28 offset:40960
    ds_read_b128 v[144:147], v28 offset:43008
    ds_read_b128 v[148:151], v28 offset:45056
    s_waitcnt lgkmcnt(9)
    v_mfma_f32_16x16x32_bf16 v[32:35], v[112:115], v[152:155], v[32:35]
    s_add_u32 m0, s28, 0
    s_nop 0
    buffer_load_dwordx4 v10, s[8:11], s29 offen lds
    v_mfma_f32_16x16x32_bf16 v[36:39], v[116:119], v[152:155], v[36:39]
    v_mfma_f32_16x16x32_bf16 v[40:43], v[120:123], v[152:155], v[40:43]
    v_mfma_f32_16x16x32_bf16 v[44:47], v[124:127], v[152:155], v[44:47]
    v_mfma_f32_16x16x32_bf16 v[48:51], v[128:131], v[152:155], v[48:51]
    s_add_u32 m0, s28, 1024
    s_nop 0
    buffer_load_dwordx4 v11, s[8:11], s29 offen lds
    v_mfma_f32_16x16x32_bf16 v[52:55], v[112:115], v[156:159], v[52:55]
    v_mfma_f32_16x16x32_bf16 v[56:59], v[116:119], v[156:159], v[56:59]
    v_mfma_f32_16x16x32_bf16 v[60:63], v[120:123], v[156:159], v[60:63]
    v_mfma_f32_16x16x32_bf16 v[64:67], v[124:127], v[156:159], v[64:67]
    s_add_u32 m0, s28, 2048
    s_nop 0
    buffer_load_dwordx4 v12, s[8:11], s29 offen lds
    v_mfma_f32_16x16x32_bf16 v[68:71], v[128:131], v[156:159], v[68:71]
    v_mfma_f32_16x16x32_bf16 v[72:75], v[112:115], v[160:163], v[72:75]
    v_mfma_f32_16x16x32_bf16 v[76:79], v[116:119], v[160:163], v[76:79]
    v_mfma_f32_16x16x32_bf16 v[80:83], v[120:123], v[160:163], v[80:83]
    s_add_u32 m0, s28, 3072
    s_nop 0
    buffer_load_dwordx4 v13, s[8:11], s29 offen lds
    v_mfma_f32_16x16x32_bf16 v[84:87], v[124:127], v[160:163], v[84:87]
    v_mfma_f32_16x16x32_bf16 v[88:91], v[128:131], v[160:163], v[88:91]
    v_mfma_f32_16x16x32_bf16 v[92:95], v[112:115], v[164:167], v[92:95]
    v_mfma_f32_16x16x32_bf16 v[96:99], v[116:119], v[164:167], v[96:99]
    s_add_u32 m0, s30, 0
    s_nop 0
    buffer_load_dwordx4 v14, s[12:15], s29 offen lds
    v_mfma_f32_16x16x32_bf16 v[100:103], v[120:123], v[164:167], v[100:103]
    v_mfma_f32_16x16x32_bf16 v[104:107], v[124:127], v[164:167], v[104:107]
    v_mfma_f32_16x16x32_bf16 v[108:111], v[128:131], v[164:167], v[108:111]
    s_add_u32 m0, s30, 1024
    s_nop 0
    buffer_load_dwordx4 v15, s[12:15], s29 offen lds
    s_add_u32 m0, s30, 2048
    s_nop 0
    buffer_load_dwordx4 v16, s[12:15], s29 offen lds
    s_add_u32 m0, s30, 3072
    s_nop 0
    buffer_load_dwordx4 v17, s[12:15], s29 offen lds
    s_add_u32 m0, s30, 4096
    s_nop 0
    buffer_load_dwordx4 v18, s[12:15], s29 offen lds
    s_add_u32 s29, s29, 128
    s_waitcnt vmcnt(18) lgkmcnt(0)
    s_barrier
    ds_read_b128 v[152:155], v20 offset:8192
    ds_read_b128 v[156:159], v20 offset:10240
    ds_read_b128 v[160:163], v20 offset:12288
    ds_read_b128 v[164:167], v20 offset:14336
    ds_read_b128 v[112:115], v26 offset:8192
    ds_read_b128 v[116:119], v26 offset:10240
    ds_read_b128 v[120:123], v26 offset:12288
    ds_read_b128 v[124:127], v26 offset:14336
    ds_read_b128 v[128:131], v26 offset:16384
    v_mfma_f32_16x16x32_bf16 v[32:35], v[132:135], v[168:171], v[32:35]
    v_mfma_f32_16x16x32_bf16 v[36:39], v[136:139], v[168:171], v[36:39]
    v_mfma_f32_16x16x32_bf16 v[40:43], v[140:143], v[168:171], v[40:43]
    v_mfma_f32_16x16x32_bf16 v[44:47], v[144:147], v[168:171], v[44:47]
    v_mfma_f32_16x16x32_bf16 v[48:51], v[148:151], v[168:171], v[48:51]
    v_mfma_f32_16x16x32_bf16 v[52:55], v[132:135], v[172:175], v[52:55]
    v_mfma_f32_16x16x32_bf16 v[56:59], v[136:139], v[172:175], v[56:59]
    v_mfma_f32_16x16x32_bf16 v[60:63], v[140:143], v[172:175], v[60:63]
    v_mfma_f32_16x16x32_bf16 v[64:67], v[144:147], v[172:175], v[64:67]
    v_mfma_f32_16x16x32_bf16 v[68:71], v[148:151], v[172:175], v[68:71]
    v_mfma_f32_16x16x32_bf16 v[72:75], v[132:135], v[176:179], v[72:75]
    v_mfma_f32_16x16x32_bf16 v[76:79], v[136:139], v[176:179], v[76:79]
    v_mfma_f32_16x16x32_bf16 v[80:83], v[140:143], v[176:179], v[80:83]
    v_mfma_f32_16x16x32_bf16 v[84:87], v[144:147], v[176:179], v[84:87]
    v_mfma_f32_16x16x32_bf16 v[88:91], v[148:151], v[176:179], v[88:91]
    v_mfma_f32_16x16x32_bf16 v[92:95], v[132:135], v[180:183], v[92:95]
    v_mfma_f32_16x16x32_bf16 v[96:99], v[136:139], v[180:183], v[96:99]
    v_mfma_f32_16x16x32_bf16 v[100:103], v[140:143], v[180:183], v[100:103]
    v_mfma_f32_16x16x32_bf16 v[104:107], v[144:147], v[180:183], v[104:107]
    v_mfma_f32_16x16x32_bf16 v[108:111], v[148:151], v[180:183], v[108:111]
    ds_read_b128 v[168:171], v23 offset:8192
    ds_read_b128 v[172:175], v23 offset:10240
    ds_read_b128 v[176:179], v23 offset:12288
    ds_read_b128 v[180:183], v23 offset:14336
    ds_read_b128 v[132:135], v29 offset:8192
    ds_read_b128 v[136:139], v29 offset:10240
    ds_read_b128 v[140:143], v29 offset:12288
    ds_read_b128 v[144:147], v29 offset:14336
    ds_read_b128 v[148:151], v29 offset:16384
    s_waitcnt lgkmcnt(9)
    v_mfma_f32_16x16x32_bf16 v[32:35], v[112:115], v[152:155], v[32:35]
    s_add_u32 m0, s28, 36864
    s_nop 0
    buffer_load_dwordx4 v10, s[8:11], s29 offen lds
    v_mfma_f32_16x16x32_bf16 v[36:39], v[116:119], v[152:155], v[36:39]
    v_mfma_f32_16x16x32_bf16 v[40:43], v[120:123], v[152:155], v[40:43]
    v_mfma_f32_16x16x32_bf16 v[44:47], v[124:127], v[152:155], v[44:47]
    v_mfma_f32_16x16x32_bf16 v[48:51], v[128:131], v[152:155], v[48:51]
    s_add_u32 m0, s28, 37888
    s_nop 0
    buffer_load_dwordx4 v11, s[8:11], s29 offen lds
    v_mfma_f32_16x16x32_bf16 v[52:55], v[112:115], v[156:159], v[52:55]
    v_mfma_f32_16x16x32_bf16 v[56:59], v[116:119], v[156:159], v[56:59]
    v_mfma_f32_16x16x32_bf16 v[60:63], v[120:123], v[156:159], v[60:63]
    v_mfma_f32_16x16x32_bf16 v[64:67], v[124:127], v[156:159], v[64:67]
    s_add_u32 m0, s28, 38912
    s_nop 0
    buffer_load_dwordx4 v12, s[8:11], s29 offen lds
    v_mfma_f32_16x16x32_bf16 v[68:71], v[128:131], v[156:159], v[68:71]
    v_mfma_f32_16x16x32_bf16 v[72:75], v[112:115], v[160:163], v[72:75]
    v_mfma_f32_16x16x32_bf16 v[76:79], v[116:119], v[160:163], v[76:79]
    v_mfma_f32_16x16x32_bf16 v[80:83], v[120:123], v[160:163], v[80:83]
    s_add_u32 m0, s28, 39936
    s_nop 0
    buffer_load_dwordx4 v13, s[8:11], s29 offen lds
    v_mfma_f32_16x16x32_bf16 v[84:87], v[124:127], v[160:163], v[84:87]
    v_mfma_f32_16x16x32_bf16 v[88:91], v[128:131], v[160:163], v[88:91]
    v_mfma_f32_16x16x32_bf16 v[92:95], v[112:115], v[164:167], v[92:95]
    v_mfma_f32_16x16x32_bf16 v[96:99], v[116:119], v[164:167], v[96:99]
    s_add_u32 m0, s30, 36864
    s_nop 0
    buffer_load_dwordx4 v14, s[12:15], s29 offen lds
    v_mfma_f32_16x16x32_bf16 v[100:103], v[120:123], v[164:167], v[100:103]
    v_mfma_f32_16x16x32_bf16 v[104:107], v[124:127], v[164:167], v[104:107]
    v_mfma_f32_16x16x32_bf16 v[108:111], v[128:131], v[164:167], v[108:111]
    s_add_u32 m0, s30, 37888
    s_nop 0
    buffer_load_dwordx4 v15, s[12:15], s29 offen lds
    s_add_u32 m0, s30, 38912
    s_nop 0
    buffer_load_dwordx4 v16, s[12:15], s29 offen lds
    s_add_u32 m0, s30, 39936
    s_nop 0
    buffer_load_dwordx4 v17, s[12:15], s29 offen lds
    s_add_u32 m0, s30, 40960
    s_nop 0
    buffer_load_dwordx4 v18, s[12:15], s29 offen lds
    s_add_u32 s29, s29, 128
    s_waitcnt vmcnt(18) lgkmcnt(0)
    s_barrier
    ds_read_b128 v[152:155], v20 offset:45056
    ds_read_b128 v[156:159], v20 offset:47104
    ds_read_b128 v[160:163], v20 offset:49152
    ds_read_b128 v[164:167], v20 offset:51200
    ds_read_b128 v[112:115], v26 offset:45056
    ds_read_b128 v[116:119], v26 offset:47104
    ds_read_b128 v[120:123], v26 offset:49152
    ds_read_b128 v[124:127], v26 offset:51200
    ds_read_b128 v[128:131], v26 offset:53248
    v_mfma_f32_16x16x32_bf16 v[32:35], v[132:135], v[168:171], v[32:35]
    v_mfma_f32_16x16x32_bf16 v[36:39], v[136:139], v[168:171], v[36:39]
    v_mfma_f32_16x16x32_bf16 v[40:43], v[140:143], v[168:171], v[40:43]
    v_mfma_f32_16x16x32_bf16 v[44:47], v[144:147], v[168:171], v[44:47]
    v_mfma_f32_16x16x32_bf16 v[48:51], v[148:151], v[168:171], v[48:51]
    v_mfma_f32_16x16x32_bf16 v[52:55], v[132:135], v[172:175], v[52:55]
    v_mfma_f32_16x16x32_bf16 v[56:59], v[136:139], v[172:175], v[56:59]
    v_mfma_f32_16x16x32_bf16 v[60:63], v[140:143], v[172:175], v[60:63]
    v_mfma_f32_16x16x32_bf16 v[64:67], v[144:147], v[172:175], v[64:67]
    v_mfma_f32_16x16x32_bf16 v[68:71], v[148:151], v[172:175], v[68:71]
    v_mfma_f32_16x16x32_bf16 v[72:75], v[132:135], v[176:179], v[72:75]
    v_mfma_f32_16x16x32_bf16 v[76:79], v[136:139], v[176:179], v[76:79]
    v_mfma_f32_16x16x32_bf16 v[80:83], v[140:143], v[176:179], v[80:83]
    v_mfma_f32_16x16x32_bf16 v[84:87], v[144:147], v[176:179], v[84:87]
    v_mfma_f32_16x16x32_bf16 v[88:91], v[148:151], v[176:179], v[88:91]
    v_mfma_f32_16x16x32_bf16 v[92:95], v[132:135], v[180:183], v[92:95]
    v_mfma_f32_16x16x32_bf16 v[96:99], v[136:139], v[180:183], v[96:99]
    v_mfma_f32_16x16x32_bf16 v[100:103], v[140:143], v[180:183], v[100:103]
    v_mfma_f32_16x16x32_bf16 v[104:107], v[144:147], v[180:183], v[104:107]
    v_mfma_f32_16x16x32_bf16 v[108:111], v[148:151], v[180:183], v[108:111]
    ds_read_b128 v[168:171], v23 offset:45056
    ds_read_b128 v[172:175], v23 offset:47104
    ds_read_b128 v[176:179], v23 offset:49152
    ds_read_b128 v[180:183], v23 offset:51200
    ds_read_b128 v[132:135], v29 offset:45056
    ds_read_b128 v[136:139], v29 offset:47104
    ds_read_b128 v[140:143], v29 offset:49152
    ds_read_b128 v[144:147], v29 offset:51200
    ds_read_b128 v[148:151], v29 offset:53248
    s_waitcnt lgkmcnt(9)
    v_mfma_f32_16x16x32_bf16 v[32:35], v[112:115], v[152:155], v[32:35]
    s_add_u32 m0, s28, 73728
    s_nop 0
    buffer_load_dwordx4 v10, s[8:11], s29 offen lds
    v_mfma_f32_16x16x32_bf16 v[36:39], v[116:119], v[152:155], v[36:39]
    v_mfma_f32_16x16x32_bf16 v[40:43], v[120:123], v[152:155], v[40:43]
    v_mfma_f32_16x16x32_bf16 v[44:47], v[124:127], v[152:155], v[44:47]
    v_mfma_f32_16x16x32_bf16 v[48:51], v[128:131], v[152:155], v[48:51]
    s_add_u32 m0, s28, 74752
    s_nop 0
    buffer_load_dwordx4 v11, s[8:11], s29 offen lds
    v_mfma_f32_16x16x32_bf16 v[52:55], v[112:115], v[156:159], v[52:55]
    v_mfma_f32_16x16x32_bf16 v[56:59], v[116:119], v[156:159], v[56:59]
    v_mfma_f32_16x16x32_bf16 v[60:63], v[120:123], v[156:159], v[60:63]
    v_mfma_f32_16x16x32_bf16 v[64:67], v[124:127], v[156:159], v[64:67]
    s_add_u32 m0, s28, 75776
    s_nop 0
    buffer_load_dwordx4 v12, s[8:11], s29 offen lds
    v_mfma_f32_16x16x32_bf16 v[68:71], v[128:131], v[156:159], v[68:71]
    v_mfma_f32_16x16x32_bf16 v[72:75], v[112:115], v[160:163], v[72:75]
    v_mfma_f32_16x16x32_bf16 v[76:79], v[116:119], v[160:163], v[76:79]
    v_mfma_f32_16x16x32_bf16 v[80:83], v[120:123], v[160:163], v[80:83]
    s_add_u32 m0, s28, 76800
    s_nop 0
    buffer_load_dwordx4 v13, s[8:11], s29 offen lds
    v_mfma_f32_16x16x32_bf16 v[84:87], v[124:127], v[160:163], v[84:87]
    v_mfma_f32_16x16x32_bf16 v[88:91], v[128:131], v[160:163], v[88:91]
    v_mfma_f32_16x16x32_bf16 v[92:95], v[112:115], v[164:167], v[92:95]
    v_mfma_f32_16x16x32_bf16 v[96:99], v[116:119], v[164:167], v[96:99]
    s_add_u32 m0, s30, 73728
    s_nop 0
    buffer_load_dwordx4 v14, s[12:15], s29 offen lds
    v_mfma_f32_16x16x32_bf16 v[100:103], v[120:123], v[164:167], v[100:103]
    v_mfma_f32_16x16x32_bf16 v[104:107], v[124:127], v[164:167], v[104:107]
    v_mfma_f32_16x16x32_bf16 v[108:111], v[128:131], v[164:167], v[108:111]
    s_add_u32 m0, s30, 74752
    s_nop 0
    buffer_load_dwordx4 v15, s[12:15], s29 offen lds
    s_add_u32 m0, s30, 75776
    s_nop 0
    buffer_load_dwordx4 v16, s[12:15], s29 offen lds
    s_add_u32 m0, s30, 76800
    s_nop 0
    buffer_load_dwordx4 v17, s[12:15], s29 offen lds
    s_add_u32 m0, s30, 77824
    s_nop 0
    buffer_load_dwordx4 v18, s[12:15], s29 offen lds
    s_add_u32 s29, s29, 128
    s_waitcnt vmcnt(18) lgkmcnt(0)
    s_barrier
    ds_read_b128 v[152:155], v19 offset:0
    ds_read_b128 v[156:159], v19 offset:2048
    ds_read_b128 v[160:163], v19 offset:4096
    ds_read_b128 v[164:167], v19 offset:6144
    ds_read_b128 v[112:115], v25 offset:0
    ds_read_b128 v[116:119], v25 offset:2048
    ds_read_b128 v[120:123], v25 offset:4096
    ds_read_b128 v[124:127], v25 offset:6144
    ds_read_b128 v[128:131], v25 offset:8192
    v_mfma_f32_16x16x32_bf16 v[32:35], v[132:135], v[168:171], v[32:35]
    v_mfma_f32_16x16x32_bf16 v[36:39], v[136:139], v[168:171], v[36:39]
    v_mfma_f32_16x16x32_bf16 v[40:43], v[140:143], v[168:171], v[40:43]
    v_mfma_f32_16x16x32_bf16 v[44:47], v[144:147], v[168:171], v[44:47]
    v_mfma_f32_16x16x32_bf16 v[48:51], v[148:151], v[168:171], v[48:51]
    v_mfma_f32_16x16x32_bf16 v[52:55], v[132:135], v[172:175], v[52:55]
    v_mfma_f32_16x16x32_bf16 v[56:59], v[136:139], v[172:175], v[56:59]
    v_mfma_f32_16x16x32_bf16 v[60:63], v[140:143], v[172:175], v[60:63]
    v_mfma_f32_16x16x32_bf16 v[64:67], v[144:147], v[172:175], v[64:67]
    v_mfma_f32_16x16x32_bf16 v[68:71], v[148:151], v[172:175], v[68:71]
    v_mfma_f32_16x16x32_bf16 v[72:75], v[132:135], v[176:179], v[72:75]
    v_mfma_f32_16x16x32_bf16 v[76:79], v[136:139], v[176:179], v[76:79]
    v_mfma_f32_16x16x32_bf16 v[80:83], v[140:143], v[176:179], v[80:83]
    v_mfma_f32_16x16x32_bf16 v[84:87], v[144:147], v[176:179], v[84:87]
    v_mfma_f32_16x16x32_bf16 v[88:91], v[148:151], v[176:179], v[88:91]
    v_mfma_f32_16x16x32_bf16 v[92:95], v[132:135], v[180:183], v[92:95]
    v_mfma_f32_16x16x32_bf16 v[96:99], v[136:139], v[180:183], v[96:99]
    v_mfma_f32_16x16x32_bf16 v[100:103], v[140:143], v[180:183], v[100:103]
    v_mfma_f32_16x16x32_bf16 v[104:107], v[144:147], v[180:183], v[104:107]
    v_mfma_f32_16x16x32_bf16 v[108:111], v[148:151], v[180:183], v[108:111]
    s_sub_u32 s31, s31, 1
    s_cmp_eq_u32 s31, 0
    s_cbranch_scc0 g2_kernel_loop
    s_waitcnt vmcnt(0) lgkmcnt(0)
    s_nop 7
    s_nop 1
    s_barrier
    s_mul_i32 s26, s23, 21504
    v_mul_u32_u24 v10, 336, v2
    v_lshl_add_u32 v10, v3, 4, v10
    v_add_u32 v10, s26, v10
    ds_write_b128 v10, v[32:35] offset:0
    ds_write_b128 v10, v[36:39] offset:64
    ds_write_b128 v10, v[40:43] offset:128
    ds_write_b128 v10, v[44:47] offset:192
    ds_write_b128 v10, v[48:51] offset:256
    ds_write_b128 v10, v[52:55] offset:5376
    ds_write_b128 v10, v[56:59] offset:5440
    ds_write_b128 v10, v[60:63] offset:5504
    ds_write_b128 v10, v[64:67] offset:5568
    ds_write_b128 v10, v[68:71] offset:5632
    ds_write_b128 v10, v[72:75] offset:10752
    ds_write_b128 v10, v[76:79] offset:10816
    ds_write_b128 v10, v[80:83] offset:10880
    ds_write_b128 v10, v[84:87] offset:10944
    ds_write_b128 v10, v[88:91] offset:11008
    ds_write_b128 v10, v[92:95] offset:16128
    ds_write_b128 v10, v[96:99] offset:16192
    ds_write_b128 v10, v[100:103] offset:16256
    ds_write_b128 v10, v[104:107] offset:16320
    ds_write_b128 v10, v[108:111] offset:16384
    s_mov_b32 s27, 0xccccccd
    v_mul_hi_u32 v11, v1, s27
    v_mul_u32_u24 v12, 20, v11
    v_sub_u32 v12, v1, v12
    s_lshl_b32 s27, s20, 7
    s_lshl_b32 s36, s34, 6
    s_add_u32 s27, s27, s36
    s_mul_i32 s27, s27, 2560
    s_mul_i32 s36, s21, 640
    s_add_u32 s27, s27, s36
    s_mul_i32 s36, s35, 320
    s_add_u32 s27, s27, s36
    s_waitcnt lgkmcnt(0)
    v_mul_u32_u24 v13, 336, v11
    v_lshl_add_u32 v13, v12, 4, v13
    v_add_u32 v13, s26, v13
    ds_read_b128 v[32:35], v13
    v_mul_u32_u24 v112, 2560, v11
    v_lshl_add_u32 v112, v12, 4, v112
    v_add_u32 v11, 3, v11
    v_add_u32 v12, 4, v12
    v_cmp_le_u32 vcc, 20, v12
    v_subrev_u32 v14, 20, v12
    v_add_u32 v15, 1, v11
    v_cndmask_b32 v12, v12, v14, vcc
    v_cndmask_b32 v11, v11, v15, vcc
    v_mul_u32_u24 v13, 336, v11
    v_lshl_add_u32 v13, v12, 4, v13
    v_add_u32 v13, s26, v13
    ds_read_b128 v[36:39], v13
    v_mul_u32_u24 v113, 2560, v11
    v_lshl_add_u32 v113, v12, 4, v113
    v_add_u32 v11, 3, v11
    v_add_u32 v12, 4, v12
    v_cmp_le_u32 vcc, 20, v12
    v_subrev_u32 v14, 20, v12
    v_add_u32 v15, 1, v11
    v_cndmask_b32 v12, v12, v14, vcc
    v_cndmask_b32 v11, v11, v15, vcc
    v_mul_u32_u24 v13, 336, v11
    v_lshl_add_u32 v13, v12, 4, v13
    v_add_u32 v13, s26, v13
    ds_read_b128 v[40:43], v13
    v_mul_u32_u24 v114, 2560, v11
    v_lshl_add_u32 v114, v12, 4, v114
    v_add_u32 v11, 3, v11
    v_add_u32 v12, 4, v12
    v_cmp_le_u32 vcc, 20, v12
    v_subrev_u32 v14, 20, v12
    v_add_u32 v15, 1, v11
    v_cndmask_b32 v12, v12, v14, vcc
    v_cndmask_b32 v11, v11, v15, vcc
    v_mul_u32_u24 v13, 336, v11
    v_lshl_add_u32 v13, v12, 4, v13
    v_add_u32 v13, s26, v13
    ds_read_b128 v[44:47], v13
    v_mul_u32_u24 v115, 2560, v11
    v_lshl_add_u32 v115, v12, 4, v115
    v_add_u32 v11, 3, v11
    v_add_u32 v12, 4, v12
    v_cmp_le_u32 vcc, 20, v12
    v_subrev_u32 v14, 20, v12
    v_add_u32 v15, 1, v11
    v_cndmask_b32 v12, v12, v14, vcc
    v_cndmask_b32 v11, v11, v15, vcc
    v_mul_u32_u24 v13, 336, v11
    v_lshl_add_u32 v13, v12, 4, v13
    v_add_u32 v13, s26, v13
    ds_read_b128 v[48:51], v13
    v_mul_u32_u24 v116, 2560, v11
    v_lshl_add_u32 v116, v12, 4, v116
    v_add_u32 v11, 3, v11
    v_add_u32 v12, 4, v12
    v_cmp_le_u32 vcc, 20, v12
    v_subrev_u32 v14, 20, v12
    v_add_u32 v15, 1, v11
    v_cndmask_b32 v12, v12, v14, vcc
    v_cndmask_b32 v11, v11, v15, vcc
    v_mul_u32_u24 v13, 336, v11
    v_lshl_add_u32 v13, v12, 4, v13
    v_add_u32 v13, s26, v13
    ds_read_b128 v[52:55], v13
    v_mul_u32_u24 v117, 2560, v11
    v_lshl_add_u32 v117, v12, 4, v117
    v_add_u32 v11, 3, v11
    v_add_u32 v12, 4, v12
    v_cmp_le_u32 vcc, 20, v12
    v_subrev_u32 v14, 20, v12
    v_add_u32 v15, 1, v11
    v_cndmask_b32 v12, v12, v14, vcc
    v_cndmask_b32 v11, v11, v15, vcc
    v_mul_u32_u24 v13, 336, v11
    v_lshl_add_u32 v13, v12, 4, v13
    v_add_u32 v13, s26, v13
    ds_read_b128 v[56:59], v13
    v_mul_u32_u24 v118, 2560, v11
    v_lshl_add_u32 v118, v12, 4, v118
    v_add_u32 v11, 3, v11
    v_add_u32 v12, 4, v12
    v_cmp_le_u32 vcc, 20, v12
    v_subrev_u32 v14, 20, v12
    v_add_u32 v15, 1, v11
    v_cndmask_b32 v12, v12, v14, vcc
    v_cndmask_b32 v11, v11, v15, vcc
    v_mul_u32_u24 v13, 336, v11
    v_lshl_add_u32 v13, v12, 4, v13
    v_add_u32 v13, s26, v13
    ds_read_b128 v[60:63], v13
    v_mul_u32_u24 v119, 2560, v11
    v_lshl_add_u32 v119, v12, 4, v119
    v_add_u32 v11, 3, v11
    v_add_u32 v12, 4, v12
    v_cmp_le_u32 vcc, 20, v12
    v_subrev_u32 v14, 20, v12
    v_add_u32 v15, 1, v11
    v_cndmask_b32 v12, v12, v14, vcc
    v_cndmask_b32 v11, v11, v15, vcc
    v_mul_u32_u24 v13, 336, v11
    v_lshl_add_u32 v13, v12, 4, v13
    v_add_u32 v13, s26, v13
    ds_read_b128 v[64:67], v13
    v_mul_u32_u24 v120, 2560, v11
    v_lshl_add_u32 v120, v12, 4, v120
    v_add_u32 v11, 3, v11
    v_add_u32 v12, 4, v12
    v_cmp_le_u32 vcc, 20, v12
    v_subrev_u32 v14, 20, v12
    v_add_u32 v15, 1, v11
    v_cndmask_b32 v12, v12, v14, vcc
    v_cndmask_b32 v11, v11, v15, vcc
    v_mul_u32_u24 v13, 336, v11
    v_lshl_add_u32 v13, v12, 4, v13
    v_add_u32 v13, s26, v13
    ds_read_b128 v[68:71], v13
    v_mul_u32_u24 v121, 2560, v11
    v_lshl_add_u32 v121, v12, 4, v121
    v_add_u32 v11, 3, v11
    v_add_u32 v12, 4, v12
    v_cmp_le_u32 vcc, 20, v12
    v_subrev_u32 v14, 20, v12
    v_add_u32 v15, 1, v11
    v_cndmask_b32 v12, v12, v14, vcc
    v_cndmask_b32 v11, v11, v15, vcc
    v_mul_u32_u24 v13, 336, v11
    v_lshl_add_u32 v13, v12, 4, v13
    v_add_u32 v13, s26, v13
    ds_read_b128 v[72:75], v13
    v_mul_u32_u24 v122, 2560, v11
    v_lshl_add_u32 v122, v12, 4, v122
    v_add_u32 v11, 3, v11
    v_add_u32 v12, 4, v12
    v_cmp_le_u32 vcc, 20, v12
    v_subrev_u32 v14, 20, v12
    v_add_u32 v15, 1, v11
    v_cndmask_b32 v12, v12, v14, vcc
    v_cndmask_b32 v11, v11, v15, vcc
    v_mul_u32_u24 v13, 336, v11
    v_lshl_add_u32 v13, v12, 4, v13
    v_add_u32 v13, s26, v13
    ds_read_b128 v[76:79], v13
    v_mul_u32_u24 v123, 2560, v11
    v_lshl_add_u32 v123, v12, 4, v123
    v_add_u32 v11, 3, v11
    v_add_u32 v12, 4, v12
    v_cmp_le_u32 vcc, 20, v12
    v_subrev_u32 v14, 20, v12
    v_add_u32 v15, 1, v11
    v_cndmask_b32 v12, v12, v14, vcc
    v_cndmask_b32 v11, v11, v15, vcc
    v_mul_u32_u24 v13, 336, v11
    v_lshl_add_u32 v13, v12, 4, v13
    v_add_u32 v13, s26, v13
    ds_read_b128 v[80:83], v13
    v_mul_u32_u24 v124, 2560, v11
    v_lshl_add_u32 v124, v12, 4, v124
    v_add_u32 v11, 3, v11
    v_add_u32 v12, 4, v12
    v_cmp_le_u32 vcc, 20, v12
    v_subrev_u32 v14, 20, v12
    v_add_u32 v15, 1, v11
    v_cndmask_b32 v12, v12, v14, vcc
    v_cndmask_b32 v11, v11, v15, vcc
    v_mul_u32_u24 v13, 336, v11
    v_lshl_add_u32 v13, v12, 4, v13
    v_add_u32 v13, s26, v13
    ds_read_b128 v[84:87], v13
    v_mul_u32_u24 v125, 2560, v11
    v_lshl_add_u32 v125, v12, 4, v125
    v_add_u32 v11, 3, v11
    v_add_u32 v12, 4, v12
    v_cmp_le_u32 vcc, 20, v12
    v_subrev_u32 v14, 20, v12
    v_add_u32 v15, 1, v11
    v_cndmask_b32 v12, v12, v14, vcc
    v_cndmask_b32 v11, v11, v15, vcc
    v_mul_u32_u24 v13, 336, v11
    v_lshl_add_u32 v13, v12, 4, v13
    v_add_u32 v13, s26, v13
    ds_read_b128 v[88:91], v13
    v_mul_u32_u24 v126, 2560, v11
    v_lshl_add_u32 v126, v12, 4, v126
    v_add_u32 v11, 3, v11
    v_add_u32 v12, 4, v12
    v_cmp_le_u32 vcc, 20, v12
    v_subrev_u32 v14, 20, v12
    v_add_u32 v15, 1, v11
    v_cndmask_b32 v12, v12, v14, vcc
    v_cndmask_b32 v11, v11, v15, vcc
    v_mul_u32_u24 v13, 336, v11
    v_lshl_add_u32 v13, v12, 4, v13
    v_add_u32 v13, s26, v13
    ds_read_b128 v[92:95], v13
    v_mul_u32_u24 v127, 2560, v11
    v_lshl_add_u32 v127, v12, 4, v127
    v_add_u32 v11, 3, v11
    v_add_u32 v12, 4, v12
    v_cmp_le_u32 vcc, 20, v12
    v_subrev_u32 v14, 20, v12
    v_add_u32 v15, 1, v11
    v_cndmask_b32 v12, v12, v14, vcc
    v_cndmask_b32 v11, v11, v15, vcc
    v_mul_u32_u24 v13, 336, v11
    v_lshl_add_u32 v13, v12, 4, v13
    v_add_u32 v13, s26, v13
    ds_read_b128 v[96:99], v13
    v_mul_u32_u24 v128, 2560, v11
    v_lshl_add_u32 v128, v12, 4, v128
    v_add_u32 v11, 3, v11
    v_add_u32 v12, 4, v12
    v_cmp_le_u32 vcc, 20, v12
    v_subrev_u32 v14, 20, v12
    v_add_u32 v15, 1, v11
    v_cndmask_b32 v12, v12, v14, vcc
    v_cndmask_b32 v11, v11, v15, vcc
    v_mul_u32_u24 v13, 336, v11
    v_lshl_add_u32 v13, v12, 4, v13
    v_add_u32 v13, s26, v13
    ds_read_b128 v[100:103], v13
    v_mul_u32_u24 v129, 2560, v11
    v_lshl_add_u32 v129, v12, 4, v129
    v_add_u32 v11, 3, v11
    v_add_u32 v12, 4, v12
    v_cmp_le_u32 vcc, 20, v12
    v_subrev_u32 v14, 20, v12
    v_add_u32 v15, 1, v11
    v_cndmask_b32 v12, v12, v14, vcc
    v_cndmask_b32 v11, v11, v15, vcc
    v_mul_u32_u24 v13, 336, v11
    v_lshl_add_u32 v13, v12, 4, v13
    v_add_u32 v13, s26, v13
    ds_read_b128 v[104:107], v13
    v_mul_u32_u24 v130, 2560, v11
    v_lshl_add_u32 v130, v12, 4, v130
    v_add_u32 v11, 3, v11
    v_add_u32 v12, 4, v12
    v_cmp_le_u32 vcc, 20, v12
    v_subrev_u32 v14, 20, v12
    v_add_u32 v15, 1, v11
    v_cndmask_b32 v12, v12, v14, vcc
    v_cndmask_b32 v11, v11, v15, vcc
    v_mul_u32_u24 v13, 336, v11
    v_lshl_add_u32 v13, v12, 4, v13
    v_add_u32 v13, s26, v13
    ds_read_b128 v[108:111], v13
    v_mul_u32_u24 v131, 2560, v11
    v_lshl_add_u32 v131, v12, 4, v131
    v_add_u32 v11, 3, v11
    v_add_u32 v12, 4, v12
    v_cmp_le_u32 vcc, 20, v12
    v_subrev_u32 v14, 20, v12
    v_add_u32 v15, 1, v11
    v_cndmask_b32 v12, v12, v14, vcc
    v_cndmask_b32 v11, v11, v15, vcc
    s_waitcnt lgkmcnt(15)
    buffer_store_dwordx4 v[32:35], v112, s[16:19], s27 offen
    s_waitcnt lgkmcnt(15)
    buffer_store_dwordx4 v[36:39], v113, s[16:19], s27 offen
    s_waitcnt lgkmcnt(15)
    buffer_store_dwordx4 v[40:43], v114, s[16:19], s27 offen
    s_waitcnt lgkmcnt(15)
    buffer_store_dwordx4 v[44:47], v115, s[16:19], s27 offen
    s_waitcnt lgkmcnt(15)
    buffer_store_dwordx4 v[48:51], v116, s[16:19], s27 offen
    s_waitcnt lgkmcnt(14)
    buffer_store_dwordx4 v[52:55], v117, s[16:19], s27 offen
    s_waitcnt lgkmcnt(13)
    buffer_store_dwordx4 v[56:59], v118, s[16:19], s27 offen
    s_waitcnt lgkmcnt(12)
    buffer_store_dwordx4 v[60:63], v119, s[16:19], s27 offen
    s_waitcnt lgkmcnt(11)
    buffer_store_dwordx4 v[64:67], v120, s[16:19], s27 offen
    s_waitcnt lgkmcnt(10)
    buffer_store_dwordx4 v[68:71], v121, s[16:19], s27 offen
    s_waitcnt lgkmcnt(9)
    buffer_store_dwordx4 v[72:75], v122, s[16:19], s27 offen
    s_waitcnt lgkmcnt(8)
    buffer_store_dwordx4 v[76:79], v123, s[16:19], s27 offen
    s_waitcnt lgkmcnt(7)
    buffer_store_dwordx4 v[80:83], v124, s[16:19], s27 offen
    s_waitcnt lgkmcnt(6)
    buffer_store_dwordx4 v[84:87], v125, s[16:19], s27 offen
    s_waitcnt lgkmcnt(5)
    buffer_store_dwordx4 v[88:91], v126, s[16:19], s27 offen
    s_waitcnt lgkmcnt(4)
    buffer_store_dwordx4 v[92:95], v127, s[16:19], s27 offen
    s_waitcnt lgkmcnt(3)
    buffer_store_dwordx4 v[96:99], v128, s[16:19], s27 offen
    s_waitcnt lgkmcnt(2)
    buffer_store_dwordx4 v[100:103], v129, s[16:19], s27 offen
    s_waitcnt lgkmcnt(1)
    buffer_store_dwordx4 v[104:107], v130, s[16:19], s27 offen
    s_waitcnt lgkmcnt(0)
    buffer_store_dwordx4 v[108:111], v131, s[16:19], s27 offen
g2_kernel_done:
    s_endpgm
.globl ln2_kernel
.p2align 8
.type ln2_kernel,@function
ln2_kernel:
    s_cmp_ge_u32 s2, 512
    s_cbranch_scc1 ln2_kernel_done
    s_load_dwordx2 s[4:5], s[0:1], 0
    s_load_dwordx2 s[6:7], s[0:1], 96
    s_load_dwordx2 s[24:25], s[0:1], 48
    s_load_dwordx2 s[26:27], s[0:1], 80
    v_lshrrev_b32 v1, 6, v0
    s_lshl_b32 s3, s2, 2
    v_add_u32 v3, s3, v1
    v_mul_u32_u24 v1, 1280, v3
    v_and_b32 v2, 63, v0
    v_lshl_add_u32 v1, v2, 2, v1
    v_lshlrev_b32 v4, 2, v2
    s_waitcnt lgkmcnt(0)
    s_mov_b32 s8, s4
    s_mov_b32 s9, s5
    s_mov_b32 s10, 0x280000
    s_mov_b32 s11, 0x00020000
    s_mov_b32 s12, s6
    s_mov_b32 s13, s7
    s_mov_b32 s14, 0x6000000
    s_mov_b32 s15, 0x00020000
    s_mov_b32 s16, s24
    s_mov_b32 s17, s25
    s_mov_b32 s18, 0x500
    s_mov_b32 s19, 0x00020000
    s_mov_b32 s28, s26
    s_mov_b32 s29, s27
    s_mov_b32 s30, 0x280000
    s_mov_b32 s31, 0x00020000
    v_lshlrev_b32 v5, 1, v1
    buffer_load_dword v10, v1, s[8:11], 0 offen offset:0
    buffer_load_dword v55, v4, s[16:19], 0 offen offset:0
    buffer_load_dword v11, v1, s[8:11], 0 offen offset:256
    buffer_load_dword v56, v4, s[16:19], 0 offen offset:256
    buffer_load_dword v12, v1, s[8:11], 0 offen offset:512
    buffer_load_dword v57, v4, s[16:19], 0 offen offset:512
    buffer_load_dword v13, v1, s[8:11], 0 offen offset:768
    buffer_load_dword v58, v4, s[16:19], 0 offen offset:768
    buffer_load_dword v14, v1, s[8:11], 0 offen offset:1024
    buffer_load_dword v59, v4, s[16:19], 0 offen offset:1024
    s_mov_b32 s20, 0x4000000
    buffer_load_dwordx2 v[64:65], v5, s[12:15], s20 offen offset:0
    buffer_load_dwordx2 v[66:67], v5, s[12:15], s20 offen offset:512
    buffer_load_dwordx2 v[68:69], v5, s[12:15], s20 offen offset:1024
    buffer_load_dwordx2 v[70:71], v5, s[12:15], s20 offen offset:1536
    buffer_load_dwordx2 v[72:73], v5, s[12:15], s20 offen offset:2048
    s_mov_b32 s20, 0x4500000
    buffer_load_dwordx2 v[74:75], v5, s[12:15], s20 offen offset:0
    buffer_load_dwordx2 v[76:77], v5, s[12:15], s20 offen offset:512
    buffer_load_dwordx2 v[78:79], v5, s[12:15], s20 offen offset:1024
    buffer_load_dwordx2 v[80:81], v5, s[12:15], s20 offen offset:1536
    buffer_load_dwordx2 v[82:83], v5, s[12:15], s20 offen offset:2048
    s_mov_b32 s20, 0x4a00000
    buffer_load_dwordx2 v[84:85], v5, s[12:15], s20 offen offset:0
    buffer_load_dwordx2 v[86:87], v5, s[12:15], s20 offen offset:512
    buffer_load_dwordx2 v[88:89], v5, s[12:15], s20 offen offset:1024
    buffer_load_dwordx2 v[90:91], v5, s[12:15], s20 offen offset:1536
    buffer_load_dwordx2 v[92:93], v5, s[12:15], s20 offen offset:2048
    s_mov_b32 s20, 0x4f00000
    buffer_load_dwordx2 v[94:95], v5, s[12:15], s20 offen offset:0
    buffer_load_dwordx2 v[96:97], v5, s[12:15], s20 offen offset:512
    buffer_load_dwordx2 v[98:99], v5, s[12:15], s20 offen offset:1024
    buffer_load_dwordx2 v[100:101], v5, s[12:15], s20 offen offset:1536
    buffer_load_dwordx2 v[102:103], v5, s[12:15], s20 offen offset:2048
    s_waitcnt vmcnt(0)
    v_add_f32 v60, v64, v84
    v_add_f32 v61, v65, v85
    v_cvt_pk_bf16_f32 v62, v60, v61
    v_lshlrev_b32 v60, 16, v62
    v_and_b32 v61, 0xffff0000, v62
    v_add_f32 v62, v74, v94
    v_add_f32 v63, v75, v95
    v_cvt_pk_bf16_f32 v46, v62, v63
    v_lshlrev_b32 v62, 16, v46
    v_and_b32 v63, 0xffff0000, v46
    v_sub_f32 v60, v60, v62
    v_sub_f32 v61, v61, v63
    v_cvt_pk_bf16_f32 v62, v60, v61
    v_lshlrev_b32 v60, 16, v62
    v_and_b32 v61, 0xffff0000, v62
    v_lshlrev_b32 v62, 16, v10
    v_and_b32 v63, 0xffff0000, v10
    v_add_f32 v60, v60, v62
    v_add_f32 v61, v61, v63
    v_cvt_pk_bf16_f32 v15, v60, v61
    v_lshlrev_b32 v20, 16, v15
    v_and_b32 v21, 0xffff0000, v15
    v_add_f32 v60, v66, v86
    v_add_f32 v61, v67, v87
    v_cvt_pk_bf16_f32 v62, v60, v61
    v_lshlrev_b32 v60, 16, v62
    v_and_b32 v61, 0xffff0000, v62
    v_add_f32 v62, v76, v96
    v_add_f32 v63, v77, v97
    v_cvt_pk_bf16_f32 v46, v62, v63
    v_lshlrev_b32 v62, 16, v46
    v_and_b32 v63, 0xffff0000, v46
    v_sub_f32 v60, v60, v62
    v_sub_f32 v61, v61, v63
    v_cvt_pk_bf16_f32 v62, v60, v61
    v_lshlrev_b32 v60, 16, v62
    v_and_b32 v61, 0xffff0000, v62
    v_lshlrev_b32 v62, 16, v11
    v_and_b32 v63, 0xffff0000, v11
    v_add_f32 v60, v60, v62
    v_add_f32 v61, v61, v63
    v_cvt_pk_bf16_f32 v16, v60, v61
    v_lshlrev_b32 v22, 16, v16
    v_and_b32 v23, 0xffff0000, v16
    v_add_f32 v60, v68, v88
    v_add_f32 v61, v69, v89
    v_cvt_pk_bf16_f32 v62, v60, v61
    v_lshlrev_b32 v60, 16, v62
    v_and_b32 v61, 0xffff0000, v62
    v_add_f32 v62, v78, v98
    v_add_f32 v63, v79, v99
    v_cvt_pk_bf16_f32 v46, v62, v63
    v_lshlrev_b32 v62, 16, v46
    v_and_b32 v63, 0xffff0000, v46
    v_sub_f32 v60, v60, v62
    v_sub_f32 v61, v61, v63
    v_cvt_pk_bf16_f32 v62, v60, v61
    v_lshlrev_b32 v60, 16, v62
    v_and_b32 v61, 0xffff0000, v62
    v_lshlrev_b32 v62, 16, v12
    v_and_b32 v63, 0xffff0000, v12
    v_add_f32 v60, v60, v62
    v_add_f32 v61, v61, v63
    v_cvt_pk_bf16_f32 v17, v60, v61
    v_lshlrev_b32 v24, 16, v17
    v_and_b32 v25, 0xffff0000, v17
    v_add_f32 v60, v70, v90
    v_add_f32 v61, v71, v91
    v_cvt_pk_bf16_f32 v62, v60, v61
    v_lshlrev_b32 v60, 16, v62
    v_and_b32 v61, 0xffff0000, v62
    v_add_f32 v62, v80, v100
    v_add_f32 v63, v81, v101
    v_cvt_pk_bf16_f32 v46, v62, v63
    v_lshlrev_b32 v62, 16, v46
    v_and_b32 v63, 0xffff0000, v46
    v_sub_f32 v60, v60, v62
    v_sub_f32 v61, v61, v63
    v_cvt_pk_bf16_f32 v62, v60, v61
    v_lshlrev_b32 v60, 16, v62
    v_and_b32 v61, 0xffff0000, v62
    v_lshlrev_b32 v62, 16, v13
    v_and_b32 v63, 0xffff0000, v13
    v_add_f32 v60, v60, v62
    v_add_f32 v61, v61, v63
    v_cvt_pk_bf16_f32 v18, v60, v61
    v_lshlrev_b32 v26, 16, v18
    v_and_b32 v27, 0xffff0000, v18
    v_add_f32 v60, v72, v92
    v_add_f32 v61, v73, v93
    v_cvt_pk_bf16_f32 v62, v60, v61
    v_lshlrev_b32 v60, 16, v62
    v_and_b32 v61, 0xffff0000, v62
    v_add_f32 v62, v82, v102
    v_add_f32 v63, v83, v103
    v_cvt_pk_bf16_f32 v46, v62, v63
    v_lshlrev_b32 v62, 16, v46
    v_and_b32 v63, 0xffff0000, v46
    v_sub_f32 v60, v60, v62
    v_sub_f32 v61, v61, v63
    v_cvt_pk_bf16_f32 v62, v60, v61
    v_lshlrev_b32 v60, 16, v62
    v_and_b32 v61, 0xffff0000, v62
    v_lshlrev_b32 v62, 16, v14
    v_and_b32 v63, 0xffff0000, v14
    v_add_f32 v60, v60, v62
    v_add_f32 v61, v61, v63
    v_cvt_pk_bf16_f32 v19, v60, v61
    v_lshlrev_b32 v28, 16, v19
    v_and_b32 v29, 0xffff0000, v19
    v_add_f32 v40, v20, v21
    v_add_f32 v40, v40, v22
    v_add_f32 v40, v40, v23
    v_add_f32 v40, v40, v24
    v_add_f32 v40, v40, v25
    v_add_f32 v40, v40, v26
    v_add_f32 v40, v40, v27
    v_add_f32 v40, v40, v28
    v_add_f32 v40, v40, v29
    s_nop 1
    v_add_f32_dpp v40, v40, v40 quad_perm:[1,0,3,2] row_mask:0xf bank_mask:0xf
    s_nop 1
    v_add_f32_dpp v40, v40, v40 quad_perm:[2,3,0,1] row_mask:0xf bank_mask:0xf
    s_nop 1
    v_add_f32_dpp v40, v40, v40 row_half_mirror row_mask:0xf bank_mask:0xf
    s_nop 1
    v_add_f32_dpp v40, v40, v40 row_mirror row_mask:0xf bank_mask:0xf
    s_nop 1
    v_add_f32_dpp v40, v40, v40 row_bcast:15 row_mask:0xa bank_mask:0xf
    s_nop 1
    v_add_f32_dpp v40, v40, v40 row_bcast:31 row_mask:0xc bank_mask:0xf
    s_nop 0
    v_readlane_b32 s20, v40, 63
    s_nop 1
    v_mov_b32 v41, s20
    v_mul_f32 v41, 0x3acccccd, v41
    v_mov_b32 v42, 0
    v_sub_f32 v43, v20, v41
    v_fmac_f32 v42, v43, v43
    v_sub_f32 v43, v21, v41
    v_fmac_f32 v42, v43, v43
    v_sub_f32 v43, v22, v41
    v_fmac_f32 v42, v43, v43
    v_sub_f32 v43, v23, v41
    v_fmac_f32 v42, v43, v43
    v_sub_f32 v43, v24, v41
    v_fmac_f32 v42, v43, v43
    v_sub_f32 v43, v25, v41
    v_fmac_f32 v42, v43, v43
    v_sub_f32 v43, v26, v41
    v_fmac_f32 v42, v43, v43
    v_sub_f32 v43, v27, v41
    v_fmac_f32 v42, v43, v43
    v_sub_f32 v43, v28, v41
    v_fmac_f32 v42, v43, v43
    v_sub_f32 v43, v29, v41
    v_fmac_f32 v42, v43, v43
    s_nop 1
    v_add_f32_dpp v42, v42, v42 quad_perm:[1,0,3,2] row_mask:0xf bank_mask:0xf
    s_nop 1
    v_add_f32_dpp v42, v42, v42 quad_perm:[2,3,0,1] row_mask:0xf bank_mask:0xf
    s_nop 1
    v_add_f32_dpp v42, v42, v42 row_half_mirror row_mask:0xf bank_mask:0xf
    s_nop 1
    v_add_f32_dpp v42, v42, v42 row_mirror row_mask:0xf bank_mask:0xf
    s_nop 1
    v_add_f32_dpp v42, v42, v42 row_bcast:15 row_mask:0xa bank_mask:0xf
    s_nop 1
    v_add_f32_dpp v42, v42, v42 row_bcast:31 row_mask:0xc bank_mask:0xf
    s_nop 0
    v_readlane_b32 s20, v42, 63
    s_nop 1
    v_mov_b32 v42, s20
    v_mul_f32 v42, 0x3acccccd, v42
    v_cvt_pk_bf16_f32 v41, v41, v41
    v_lshlrev_b32 v41, 16, v41
    v_cvt_pk_bf16_f32 v42, v42, v42
    v_lshlrev_b32 v42, 16, v42
    v_add_f32 v42, 0x3727c5ac, v42
    v_cvt_pk_bf16_f32 v42, v42, v42
    v_lshlrev_b32 v42, 16, v42
    v_sqrt_f32 v42, v42
    s_nop 0
    v_cvt_pk_bf16_f32 v42, v42, v42
    v_lshlrev_b32 v42, 16, v42
    v_rcp_f32 v43, v42
    s_nop 0
    v_sub_f32 v44, v20, v41
    v_sub_f32 v45, v21, v41
    v_cvt_pk_bf16_f32 v44, v44, v45
    v_lshlrev_b32 v30, 16, v44
    v_and_b32 v31, 0xffff0000, v44
    v_sub_f32 v44, v22, v41
    v_sub_f32 v45, v23, v41
    v_cvt_pk_bf16_f32 v44, v44, v45
    v_lshlrev_b32 v32, 16, v44
    v_and_b32 v33, 0xffff0000, v44
    v_sub_f32 v44, v24, v41
    v_sub_f32 v45, v25, v41
    v_cvt_pk_bf16_f32 v44, v44, v45
    v_lshlrev_b32 v34, 16, v44
    v_and_b32 v35, 0xffff0000, v44
    v_sub_f32 v44, v26, v41
    v_sub_f32 v45, v27, v41
    v_cvt_pk_bf16_f32 v44, v44, v45
    v_lshlrev_b32 v36, 16, v44
    v_and_b32 v37, 0xffff0000, v44
    v_sub_f32 v44, v28, v41
    v_sub_f32 v45, v29, v41
    v_cvt_pk_bf16_f32 v44, v44, v45
    v_lshlrev_b32 v38, 16, v44
    v_and_b32 v39, 0xffff0000, v44
    v_mul_f32 v44, v30, v43
    v_fma_f32 v45, -v44, v42, v30
    v_fma_f32 v30, v45, v43, v44
    v_mul_f32 v44, v31, v43
    v_fma_f32 v45, -v44, v42, v31
    v_fma_f32 v31, v45, v43, v44
    v_mul_f32 v44, v32, v43
    v_fma_f32 v45, -v44, v42, v32
    v_fma_f32 v32, v45, v43, v44
    v_mul_f32 v44, v33, v43
    v_fma_f32 v45, -v44, v42, v33
    v_fma_f32 v33, v45, v43, v44
    v_mul_f32 v44, v34, v43
    v_fma_f32 v45, -v44, v42, v34
    v_fma_f32 v34, v45, v43, v44
    v_mul_f32 v44, v35, v43
    v_fma_f32 v45, -v44, v42, v35
    v_fma_f32 v35, v45, v43, v44
    v_mul_f32 v44, v36, v43
    v_fma_f32 v45, -v44, v42, v36
    v_fma_f32 v36, v45, v43, v44
    v_mul_f32 v44, v37, v43
    v_fma_f32 v45, -v44, v42, v37
    v_fma_f32 v37, v45, v43, v44
    v_mul_f32 v44, v38, v43
    v_fma_f32 v45, -v44, v42, v38
    v_fma_f32 v38, v45, v43, v44
    v_mul_f32 v44, v39, v43
    v_fma_f32 v45, -v44, v42, v39
    v_fma_f32 v39, v45, v43, v44
    v_cvt_pk_bf16_f32 v44, v30, v31
    v_lshlrev_b32 v30, 16, v44
    v_and_b32 v31, 0xffff0000, v44
    v_cvt_pk_bf16_f32 v44, v32, v33
    v_lshlrev_b32 v32, 16, v44
    v_and_b32 v33, 0xffff0000, v44
    v_cvt_pk_bf16_f32 v44, v34, v35
    v_lshlrev_b32 v34, 16, v44
    v_and_b32 v35, 0xffff0000, v44
    v_cvt_pk_bf16_f32 v44, v36, v37
    v_lshlrev_b32 v36, 16, v44
    v_and_b32 v37, 0xffff0000, v44
    v_cvt_pk_bf16_f32 v44, v38, v39
    v_lshlrev_b32 v38, 16, v44
    v_and_b32 v39, 0xffff0000, v44
    v_mov_b32 v40, 0
    v_lshlrev_b32 v60, 16, v55
    v_and_b32 v61, 0xffff0000, v55
    v_fmac_f32 v40, v60, v30
    v_fmac_f32 v40, v61, v31
    v_lshlrev_b32 v60, 16, v56
    v_and_b32 v61, 0xffff0000, v56
    v_fmac_f32 v40, v60, v32
    v_fmac_f32 v40, v61, v33
    v_lshlrev_b32 v60, 16, v57
    v_and_b32 v61, 0xffff0000, v57
    v_fmac_f32 v40, v60, v34
    v_fmac_f32 v40, v61, v35
    v_lshlrev_b32 v60, 16, v58
    v_and_b32 v61, 0xffff0000, v58
    v_fmac_f32 v40, v60, v36
    v_fmac_f32 v40, v61, v37
    v_lshlrev_b32 v60, 16, v59
    v_and_b32 v61, 0xffff0000, v59
    v_fmac_f32 v40, v60, v38
    v_fmac_f32 v40, v61, v39
    s_nop 1
    v_add_f32_dpp v40, v40, v40 quad_perm:[1,0,3,2] row_mask:0xf bank_mask:0xf
    s_nop 1
    v_add_f32_dpp v40, v40, v40 quad_perm:[2,3,0,1] row_mask:0xf bank_mask:0xf
    s_nop 1
    v_add_f32_dpp v40, v40, v40 row_half_mirror row_mask:0xf bank_mask:0xf
    s_nop 1
    v_add_f32_dpp v40, v40, v40 row_mirror row_mask:0xf bank_mask:0xf
    s_nop 1
    v_add_f32_dpp v40, v40, v40 row_bcast:15 row_mask:0xa bank_mask:0xf
    s_nop 1
    v_add_f32_dpp v40, v40, v40 row_bcast:31 row_mask:0xc bank_mask:0xf
    s_nop 0
    v_readlane_b32 s20, v40, 63
    s_nop 1
    v_mov_b32 v40, s20
    v_cvt_pk_bf16_f32 v40, v40, v40
    s_mov_b32 s20, 0x1400000
    s_mov_b32 s21, 0x1800000
    v_cvt_pk_bf16_f32 v50, v30, v31
    v_add_f32 v60, v20, v30
    v_add_f32 v61, v21, v31
    v_cvt_pk_bf16_f32 v10, v60, v61
    buffer_store_dword v10, v1, s[28:31], 0 offen offset:0
    buffer_store_dword v15, v1, s[12:15], s20 offen offset:0
    buffer_store_dword v50, v1, s[12:15], s21 offen offset:0
    v_cvt_pk_bf16_f32 v51, v32, v33
    v_add_f32 v60, v22, v32
    v_add_f32 v61, v23, v33
    v_cvt_pk_bf16_f32 v11, v60, v61
    buffer_store_dword v11, v1, s[28:31], 0 offen offset:256
    buffer_store_dword v16, v1, s[12:15], s20 offen offset:256
    buffer_store_dword v51, v1, s[12:15], s21 offen offset:256
    v_cvt_pk_bf16_f32 v52, v34, v35
    v_add_f32 v60, v24, v34
    v_add_f32 v61, v25, v35
    v_cvt_pk_bf16_f32 v12, v60, v61
    buffer_store_dword v12, v1, s[28:31], 0 offen offset:512
    buffer_store_dword v17, v1, s[12:15], s20 offen offset:512
    buffer_store_dword v52, v1, s[12:15], s21 offen offset:512
    v_cvt_pk_bf16_f32 v53, v36, v37
    v_add_f32 v60, v26, v36
    v_add_f32 v61, v27, v37
    v_cvt_pk_bf16_f32 v13, v60, v61
    buffer_store_dword v13, v1, s[28:31], 0 offen offset:768
    buffer_store_dword v18, v1, s[12:15], s20 offen offset:768
    buffer_store_dword v53, v1, s[12:15], s21 offen offset:768
    v_cvt_pk_bf16_f32 v54, v38, v39
    v_add_f32 v60, v28, v38
    v_add_f32 v61, v29, v39
    v_cvt_pk_bf16_f32 v14, v60, v61
    buffer_store_dword v14, v1, s[28:31], 0 offen offset:1024
    buffer_store_dword v19, v1, s[12:15], s20 offen offset:1024
    buffer_store_dword v54, v1, s[12:15], s21 offen offset:1024
    s_cmp_lg_u32 s2, 0
    s_cbranch_scc1 ln2_kernel_nz
    v_lshlrev_b32 v60, 4, v0
    v_mov_b32 v64, 0
    v_mov_b32 v65, 0
    v_mov_b32 v66, 0
    v_mov_b32 v67, 0
    s_mov_b32 s20, 0x1c10000
    buffer_store_dwordx4 v[64:67], v60, s[12:15], s20 offen sc1
    s_add_u32 s20, s20, 4096
    buffer_store_dwordx4 v[64:67], v60, s[12:15], s20 offen sc1
    s_add_u32 s20, s20, 4096
    buffer_store_dwordx4 v[64:67], v60, s[12:15], s20 offen sc1
    s_add_u32 s20, s20, 4096
    buffer_store_dwordx4 v[64:67], v60, s[12:15], s20 offen sc1
    s_add_u32 s20, s20, 4096
    buffer_store_dwordx4 v[64:67], v60, s[12:15], s20 offen sc1
    s_add_u32 s20, s20, 4096
ln2_kernel_nz:
    v_lshlrev_b32 v3, 1, v3
    s_mov_b32 s20, 0x1c00000
    v_cmp_eq_u32 vcc, 0, v2
    s_and_saveexec_b64 s[22:23], vcc
    buffer_store_short v40, v3, s[12:15], s20 offen
ln2_kernel_done:
    s_endpgm
.globl ffn1_kernel
.p2align 8
.type ffn1_kernel,@function
ffn1_kernel:
    s_cmp_ge_u32 s2, 96
    s_cbranch_scc1 ffn1_kernel_done
    s_load_dwordx2 s[4:5], s[0:1], 56
    s_load_dwordx2 s[6:7], s[0:1], 64
    s_load_dwordx2 s[24:25], s[0:1], 96
    s_load_dwordx2 s[50:51], s[0:1], 72
    s_load_dwordx4 s[52:55], s[0:1], 80
    v_and_b32 v1, 63, v0
    v_and_b32 v2, 15, v0
    v_lshrrev_b32 v3, 4, v1
    v_lshrrev_b32 v4, 6, v0
    s_waitcnt lgkmcnt(0)
    s_mov_b32 s8, s4
    s_mov_b32 s9, s5
    s_mov_b32 s10, 0x1e0000
    s_mov_b32 s11, 0x00020000
    s_mov_b32 s12, s6
    s_mov_b32 s13, s7
    s_mov_b32 s14, 0x1e0000
    s_mov_b32 s15, 0x00020000
    s_mov_b32 s16, s24
    s_mov_b32 s17, s25
    s_mov_b32 s18, 0x6000000
    s_mov_b32 s19, 0x00020000
    s_mov_b32 s56, s50
    s_mov_b32 s57, s51
    s_mov_b32 s58, 0x1e0000
    s_mov_b32 s59, 0x00020000
    s_mov_b32 s60, s52
    s_mov_b32 s61, s53
    s_mov_b32 s62, 0x280000
    s_mov_b32 s63, 0x00020000
    s_mov_b32 s64, s54
    s_mov_b32 s65, s55
    s_mov_b32 s66, 0x100
    s_mov_b32 s67, 0x00020000
    v_lshlrev_b32 v5, 4, v0
    s_mov_b32 s20, 0x1c00000
    buffer_load_dwordx4 v[8:11], v5, s[16:19], s20 offen
    v_mul_u32_u24 v5, 160, v4
    v_lshl_add_u32 v5, v3, 3, v5
    v_mul_u32_u24 v5, 3072, v5
    s_lshl_b32 s20, s2, 4
    v_add_u32 v6, s20, v2
    v_lshl_add_u32 v5, v6, 1, v5
    s_mov_b32 s20, 0
    buffer_load_ushort v128, v5, s[8:11], s20 offen
    buffer_load_ushort v168, v5, s[12:15], s20 offen
    s_mov_b32 s20, 3072
    buffer_load_ushort v129, v5, s[8:11], s20 offen
    buffer_load_ushort v169, v5, s[12:15], s20 offen
    s_mov_b32 s20, 6144
    buffer_load_ushort v130, v5, s[8:11], s20 offen
    buffer_load_ushort v170, v5, s[12:15], s20 offen
    s_mov_b32 s20, 9216
    buffer_load_ushort v131, v5, s[8:11], s20 offen
    buffer_load_ushort v171, v5, s[12:15], s20 offen
    s_mov_b32 s20, 12288
    buffer_load_ushort v132, v5, s[8:11], s20 offen
    buffer_load_ushort v172, v5, s[12:15], s20 offen
    s_mov_b32 s20, 15360
    buffer_load_ushort v133, v5, s[8:11], s20 offen
    buffer_load_ushort v173, v5, s[12:15], s20 offen
    s_mov_b32 s20, 18432
    buffer_load_ushort v134, v5, s[8:11], s20 offen
    buffer_load_ushort v174, v5, s[12:15], s20 offen
    s_mov_b32 s20, 21504
    buffer_load_ushort v135, v5, s[8:11], s20 offen
    buffer_load_ushort v175, v5, s[12:15], s20 offen
    s_mov_b32 s20, 98304
    buffer_load_ushort v136, v5, s[8:11], s20 offen
    buffer_load_ushort v176, v5, s[12:15], s20 offen
    s_mov_b32 s20, 101376
    buffer_load_ushort v137, v5, s[8:11], s20 offen
    buffer_load_ushort v177, v5, s[12:15], s20 offen
    s_mov_b32 s20, 104448
    buffer_load_ushort v138, v5, s[8:11], s20 offen
    buffer_load_ushort v178, v5, s[12:15], s20 offen
    s_mov_b32 s20, 107520
    buffer_load_ushort v139, v5, s[8:11], s20 offen
    buffer_load_ushort v179, v5, s[12:15], s20 offen
    s_mov_b32 s20, 110592
    buffer_load_ushort v140, v5, s[8:11], s20 offen
    buffer_load_ushort v180, v5, s[12:15], s20 offen
    s_mov_b32 s20, 113664
    buffer_load_ushort v141, v5, s[8:11], s20 offen
    buffer_load_ushort v181, v5, s[12:15], s20 offen
    s_mov_b32 s20, 116736
    buffer_load_ushort v142, v5, s[8:11], s20 offen
    buffer_load_ushort v182, v5, s[12:15], s20 offen
    s_mov_b32 s20, 119808
    buffer_load_ushort v143, v5, s[8:11], s20 offen
    buffer_load_ushort v183, v5, s[12:15], s20 offen
    s_mov_b32 s20, 196608
    buffer_load_ushort v144, v5, s[8:11], s20 offen
    buffer_load_ushort v184, v5, s[12:15], s20 offen
    s_mov_b32 s20, 199680
    buffer_load_ushort v145, v5, s[8:11], s20 offen
    buffer_load_ushort v185, v5, s[12:15], s20 offen
    s_mov_b32 s20, 202752
    buffer_load_ushort v146, v5, s[8:11], s20 offen
    buffer_load_ushort v186, v5, s[12:15], s20 offen
    s_mov_b32 s20, 205824
    buffer_load_ushort v147, v5, s[8:11], s20 offen
    buffer_load_ushort v187, v5, s[12:15], s20 offen
    s_mov_b32 s20, 208896
    buffer_load_ushort v148, v5, s[8:11], s20 offen
    buffer_load_ushort v188, v5, s[12:15], s20 offen
    s_mov_b32 s20, 211968
    buffer_load_ushort v149, v5, s[8:11], s20 offen
    buffer_load_ushort v189, v5, s[12:15], s20 offen
    s_mov_b32 s20, 215040
    buffer_load_ushort v150, v5, s[8:11], s20 offen
    buffer_load_ushort v190, v5, s[12:15], s20 offen
    s_mov_b32 s20, 218112
    buffer_load_ushort v151, v5, s[8:11], s20 offen
    buffer_load_ushort v191, v5, s[12:15], s20 offen
    s_mov_b32 s20, 294912
    buffer_load_ushort v152, v5, s[8:11], s20 offen
    buffer_load_ushort v192, v5, s[12:15], s20 offen
    s_mov_b32 s20, 297984
    buffer_load_ushort v153, v5, s[8:11], s20 offen
    buffer_load_ushort v193, v5, s[12:15], s20 offen
    s_mov_b32 s20, 301056
    buffer_load_ushort v154, v5, s[8:11], s20 offen
    buffer_load_ushort v194, v5, s[12:15], s20 offen
    s_mov_b32 s20, 304128
    buffer_load_ushort v155, v5, s[8:11], s20 offen
    buffer_load_ushort v195, v5, s[12:15], s20 offen
    s_mov_b32 s20, 307200
    buffer_load_ushort v156, v5, s[8:11], s20 offen
    buffer_load_ushort v196, v5, s[12:15], s20 offen
    s_mov_b32 s20, 310272
    buffer_load_ushort v157, v5, s[8:11], s20 offen
    buffer_load_ushort v197, v5, s[12:15], s20 offen
    s_mov_b32 s20, 313344
    buffer_load_ushort v158, v5, s[8:11], s20 offen
    buffer_load_ushort v198, v5, s[12:15], s20 offen
    s_mov_b32 s20, 316416
    buffer_load_ushort v159, v5, s[8:11], s20 offen
    buffer_load_ushort v199, v5, s[12:15], s20 offen
    s_mov_b32 s20, 393216
    buffer_load_ushort v160, v5, s[8:11], s20 offen
    buffer_load_ushort v200, v5, s[12:15], s20 offen
    s_mov_b32 s20, 396288
    buffer_load_ushort v161, v5, s[8:11], s20 offen
    buffer_load_ushort v201, v5, s[12:15], s20 offen
    s_mov_b32 s20, 399360
    buffer_load_ushort v162, v5, s[8:11], s20 offen
    buffer_load_ushort v202, v5, s[12:15], s20 offen
    s_mov_b32 s20, 402432
    buffer_load_ushort v163, v5, s[8:11], s20 offen
    buffer_load_ushort v203, v5, s[12:15], s20 offen
    s_mov_b32 s20, 405504
    buffer_load_ushort v164, v5, s[8:11], s20 offen
    buffer_load_ushort v204, v5, s[12:15], s20 offen
    s_mov_b32 s20, 408576
    buffer_load_ushort v165, v5, s[8:11], s20 offen
    buffer_load_ushort v205, v5, s[12:15], s20 offen
    s_mov_b32 s20, 411648
    buffer_load_ushort v166, v5, s[8:11], s20 offen
    buffer_load_ushort v206, v5, s[12:15], s20 offen
    s_mov_b32 s20, 414720
    buffer_load_ushort v167, v5, s[8:11], s20 offen
    buffer_load_ushort v207, v5, s[12:15], s20 offen
    s_mul_i32 s20, s2, 20480
    v_lshlrev_b32 v7, 4, v0
    buffer_load_dwordx4 v[208:211], v7, s[56:59], s20 offen
    s_add_u32 s20, s20, 4096
    buffer_load_dwordx4 v[212:215], v7, s[56:59], s20 offen
    s_add_u32 s20, s20, 4096
    buffer_load_dwordx4 v[216:219], v7, s[56:59], s20 offen
    s_add_u32 s20, s20, 4096
    buffer_load_dwordx4 v[220:223], v7, s[56:59], s20 offen
    s_add_u32 s20, s20, 4096
    buffer_load_dwordx4 v[224:227], v7, s[56:59], s20 offen
    s_add_u32 s20, s20, 4096
    s_mov_b32 s21, 0x7fff
    v_lshlrev_b32 v6, 3, v0
    v_sub_u32 v6, 2047, v6
    s_waitcnt vmcnt(63)
    v_and_b32 v20, 0xffff, v8
    v_bfe_i32 v21, v20, 15, 1
    v_and_b32 v21, s21, v21
    v_or_b32 v21, 0x8000, v21
    v_xor_b32 v20, v20, v21
    v_subrev_u32 v21, 0, v6
    v_lshl_or_b32 v24, v20, 11, v21
    v_lshrrev_b32 v20, 16, v8
    v_bfe_i32 v21, v20, 15, 1
    v_and_b32 v21, s21, v21
    v_or_b32 v21, 0x8000, v21
    v_xor_b32 v20, v20, v21
    v_subrev_u32 v21, 1, v6
    v_lshl_or_b32 v25, v20, 11, v21
    v_and_b32 v20, 0xffff, v9
    v_bfe_i32 v21, v20, 15, 1
    v_and_b32 v21, s21, v21
    v_or_b32 v21, 0x8000, v21
    v_xor_b32 v20, v20, v21
    v_subrev_u32 v21, 2, v6
    v_lshl_or_b32 v26, v20, 11, v21
    v_lshrrev_b32 v20, 16, v9
    v_bfe_i32 v21, v20, 15, 1
    v_and_b32 v21, s21, v21
    v_or_b32 v21, 0x8000, v21
    v_xor_b32 v20, v20, v21
    v_subrev_u32 v21, 3, v6
    v_lshl_or_b32 v27, v20, 11, v21
    v_and_b32 v20, 0xffff, v10
    v_bfe_i32 v21, v20, 15, 1
    v_and_b32 v21, s21, v21
    v_or_b32 v21, 0x8000, v21
    v_xor_b32 v20, v20, v21
    v_subrev_u32 v21, 4, v6
    v_lshl_or_b32 v28, v20, 11, v21
    v_lshrrev_b32 v20, 16, v10
    v_bfe_i32 v21, v20, 15, 1
    v_and_b32 v21, s21, v21
    v_or_b32 v21, 0x8000, v21
    v_xor_b32 v20, v20, v21
    v_subrev_u32 v21, 5, v6
    v_lshl_or_b32 v29, v20, 11, v21
    v_and_b32 v20, 0xffff, v11
    v_bfe_i32 v21, v20, 15, 1
    v_and_b32 v21, s21, v21
    v_or_b32 v21, 0x8000, v21
    v_xor_b32 v20, v20, v21
    v_subrev_u32 v21, 6, v6
    v_lshl_or_b32 v30, v20, 11, v21
    v_lshrrev_b32 v20, 16, v11
    v_bfe_i32 v21, v20, 15, 1
    v_and_b32 v21, s21, v21
    v_or_b32 v21, 0x8000, v21
    v_xor_b32 v20, v20, v21
    v_subrev_u32 v21, 7, v6
    v_lshl_or_b32 v31, v20, 11, v21
    v_max3_u32 v20, v24, v25, v26
    v_max3_u32 v20, v20, v27, v28
    v_max3_u32 v20, v20, v29, v30
    v_max_u32 v20, v20, v31
    s_nop 1
    v_max_u32_dpp v20, v20, v20 quad_perm:[1,0,3,2] row_mask:0xf bank_mask:0xf
    s_nop 1
    v_max_u32_dpp v20, v20, v20 quad_perm:[2,3,0,1] row_mask:0xf bank_mask:0xf
    s_nop 1
    v_max_u32_dpp v20, v20, v20 row_half_mirror row_mask:0xf bank_mask:0xf
    s_nop 1
    v_max_u32_dpp v20, v20, v20 row_mirror row_mask:0xf bank_mask:0xf
    s_nop 1
    v_max_u32_dpp v20, v20, v20 row_bcast:15 row_mask:0xa bank_mask:0xf
    s_nop 1
    v_max_u32_dpp v20, v20, v20 row_bcast:31 row_mask:0xc bank_mask:0xf
    s_nop 0
    v_readlane_b32 s20, v20, 63
    s_nop 1
    v_mov_b32 v20, s20
    v_lshlrev_b32 v21, 2, v4
    ds_write_b32 v21, v20 offset:0
    s_waitcnt lgkmcnt(0)
    s_barrier
    v_mov_b32 v21, 0
    ds_read_b128 v[32:35], v21 offset:0
    s_waitcnt lgkmcnt(0)
    v_max3_u32 v20, v32, v33, v34
    v_max_u32 v20, v20, v35
    v_cmp_eq_u32 vcc, v20, v24
    s_nop 1
    v_cndmask_b32_e64 v24, v24, 0, vcc
    v_cmp_eq_u32 vcc, v20, v25
    s_nop 1
    v_cndmask_b32_e64 v25, v25, 0, vcc
    v_cmp_eq_u32 vcc, v20, v26
    s_nop 1
    v_cndmask_b32_e64 v26, v26, 0, vcc
    v_cmp_eq_u32 vcc, v20, v27
    s_nop 1
    v_cndmask_b32_e64 v27, v27, 0, vcc
    v_cmp_eq_u32 vcc, v20, v28
    s_nop 1
    v_cndmask_b32_e64 v28, v28, 0, vcc
    v_cmp_eq_u32 vcc, v20, v29
    s_nop 1
    v_cndmask_b32_e64 v29, v29, 0, vcc
    v_cmp_eq_u32 vcc, v20, v30
    s_nop 1
    v_cndmask_b32_e64 v30, v30, 0, vcc
    v_cmp_eq_u32 vcc, v20, v31
    s_nop 1
    v_cndmask_b32_e64 v31, v31, 0, vcc
    v_and_b32 v21, 2047, v20
    v_sub_u32 v21, 2047, v21
    s_nop 0
    v_readfirstlane_b32 s40, v21
    v_max3_u32 v20, v24, v25, v26
    v_max3_u32 v20, v20, v27, v28
    v_max3_u32 v20, v20, v29, v30
    v_max_u32 v20, v20, v31
    s_nop 1
    v_max_u32_dpp v20, v20, v20 quad_perm:[1,0,3,2] row_mask:0xf bank_mask:0xf
    s_nop 1
    v_max_u32_dpp v20, v20, v20 quad_perm:[2,3,0,1] row_mask:0xf bank_mask:0xf
    s_nop 1
    v_max_u32_dpp v20, v20, v20 row_half_mirror row_mask:0xf bank_mask:0xf
    s_nop 1
    v_max_u32_dpp v20, v20, v20 row_mirror row_mask:0xf bank_mask:0xf
    s_nop 1
    v_max_u32_dpp v20, v20, v20 row_bcast:15 row_mask:0xa bank_mask:0xf
    s_nop 1
    v_max_u32_dpp v20, v20, v20 row_bcast:31 row_mask:0xc bank_mask:0xf
    s_nop 0
    v_readlane_b32 s20, v20, 63
    s_nop 1
    v_mov_b32 v20, s20
    v_lshlrev_b32 v21, 2, v4
    ds_write_b32 v21, v20 offset:16
    s_waitcnt lgkmcnt(0)
    s_barrier
    v_mov_b32 v21, 0
    ds_read_b128 v[32:35], v21 offset:16
    s_waitcnt lgkmcnt(0)
    v_max3_u32 v20, v32, v33, v34
    v_max_u32 v20, v20, v35
    v_cmp_eq_u32 vcc, v20, v24
    s_nop 1
    v_cndmask_b32_e64 v24, v24, 0, vcc
    v_cmp_eq_u32 vcc, v20, v25
    s_nop 1
    v_cndmask_b32_e64 v25, v25, 0, vcc
    v_cmp_eq_u32 vcc, v20, v26
    s_nop 1
    v_cndmask_b32_e64 v26, v26, 0, vcc
    v_cmp_eq_u32 vcc, v20, v27
    s_nop 1
    v_cndmask_b32_e64 v27, v27, 0, vcc
    v_cmp_eq_u32 vcc, v20, v28
    s_nop 1
    v_cndmask_b32_e64 v28, v28, 0, vcc
    v_cmp_eq_u32 vcc, v20, v29
    s_nop 1
    v_cndmask_b32_e64 v29, v29, 0, vcc
    v_cmp_eq_u32 vcc, v20, v30
    s_nop 1
    v_cndmask_b32_e64 v30, v30, 0, vcc
    v_cmp_eq_u32 vcc, v20, v31
    s_nop 1
    v_cndmask_b32_e64 v31, v31, 0, vcc
    v_and_b32 v21, 2047, v20
    v_sub_u32 v21, 2047, v21
    s_nop 0
    v_readfirstlane_b32 s41, v21
    v_max3_u32 v20, v24, v25, v26
    v_max3_u32 v20, v20, v27, v28
    v_max3_u32 v20, v20, v29, v30
    v_max_u32 v20, v20, v31
    s_nop 1
    v_max_u32_dpp v20, v20, v20 quad_perm:[1,0,3,2] row_mask:0xf bank_mask:0xf
    s_nop 1
    v_max_u32_dpp v20, v20, v20 quad_perm:[2,3,0,1] row_mask:0xf bank_mask:0xf
    s_nop 1
    v_max_u32_dpp v20, v20, v20 row_half_mirror row_mask:0xf bank_mask:0xf
    s_nop 1
    v_max_u32_dpp v20, v20, v20 row_mirror row_mask:0xf bank_mask:0xf
    s_nop 1
    v_max_u32_dpp v20, v20, v20 row_bcast:15 row_mask:0xa bank_mask:0xf
    s_nop 1
    v_max_u32_dpp v20, v20, v20 row_bcast:31 row_mask:0xc bank_mask:0xf
    s_nop 0
    v_readlane_b32 s20, v20, 63
    s_nop 1
    v_mov_b32 v20, s20
    v_lshlrev_b32 v21, 2, v4
    ds_write_b32 v21, v20 offset:32
    s_waitcnt lgkmcnt(0)
    s_barrier
    v_mov_b32 v21, 0
    ds_read_b128 v[32:35], v21 offset:32
    s_waitcnt lgkmcnt(0)
    v_max3_u32 v20, v32, v33, v34
    v_max_u32 v20, v20, v35
    v_cmp_eq_u32 vcc, v20, v24
    s_nop 1
    v_cndmask_b32_e64 v24, v24, 0, vcc
    v_cmp_eq_u32 vcc, v20, v25
    s_nop 1
    v_cndmask_b32_e64 v25, v25, 0, vcc
    v_cmp_eq_u32 vcc, v20, v26
    s_nop 1
    v_cndmask_b32_e64 v26, v26, 0, vcc
    v_cmp_eq_u32 vcc, v20, v27
    s_nop 1
    v_cndmask_b32_e64 v27, v27, 0, vcc
    v_cmp_eq_u32 vcc, v20, v28
    s_nop 1
    v_cndmask_b32_e64 v28, v28, 0, vcc
    v_cmp_eq_u32 vcc, v20, v29
    s_nop 1
    v_cndmask_b32_e64 v29, v29, 0, vcc
    v_cmp_eq_u32 vcc, v20, v30
    s_nop 1
    v_cndmask_b32_e64 v30, v30, 0, vcc
    v_cmp_eq_u32 vcc, v20, v31
    s_nop 1
    v_cndmask_b32_e64 v31, v31, 0, vcc
    v_and_b32 v21, 2047, v20
    v_sub_u32 v21, 2047, v21
    s_nop 0
    v_readfirstlane_b32 s42, v21
    v_max3_u32 v20, v24, v25, v26
    v_max3_u32 v20, v20, v27, v28
    v_max3_u32 v20, v20, v29, v30
    v_max_u32 v20, v20, v31
    s_nop 1
    v_max_u32_dpp v20, v20, v20 quad_perm:[1,0,3,2] row_mask:0xf bank_mask:0xf
    s_nop 1
    v_max_u32_dpp v20, v20, v20 quad_perm:[2,3,0,1] row_mask:0xf bank_mask:0xf
    s_nop 1
    v_max_u32_dpp v20, v20, v20 row_half_mirror row_mask:0xf bank_mask:0xf
    s_nop 1
    v_max_u32_dpp v20, v20, v20 row_mirror row_mask:0xf bank_mask:0xf
    s_nop 1
    v_max_u32_dpp v20, v20, v20 row_bcast:15 row_mask:0xa bank_mask:0xf
    s_nop 1
    v_max_u32_dpp v20, v20, v20 row_bcast:31 row_mask:0xc bank_mask:0xf
    s_nop 0
    v_readlane_b32 s20, v20, 63
    s_nop 1
    v_mov_b32 v20, s20
    v_lshlrev_b32 v21, 2, v4
    ds_write_b32 v21, v20 offset:48
    s_waitcnt lgkmcnt(0)
    s_barrier
    v_mov_b32 v21, 0
    ds_read_b128 v[32:35], v21 offset:48
    s_waitcnt lgkmcnt(0)
    v_max3_u32 v20, v32, v33, v34
    v_max_u32 v20, v20, v35
    v_cmp_eq_u32 vcc, v20, v24
    s_nop 1
    v_cndmask_b32_e64 v24, v24, 0, vcc
    v_cmp_eq_u32 vcc, v20, v25
    s_nop 1
    v_cndmask_b32_e64 v25, v25, 0, vcc
    v_cmp_eq_u32 vcc, v20, v26
    s_nop 1
    v_cndmask_b32_e64 v26, v26, 0, vcc
    v_cmp_eq_u32 vcc, v20, v27
    s_nop 1
    v_cndmask_b32_e64 v27, v27, 0, vcc
    v_cmp_eq_u32 vcc, v20, v28
    s_nop 1
    v_cndmask_b32_e64 v28, v28, 0, vcc
    v_cmp_eq_u32 vcc, v20, v29
    s_nop 1
    v_cndmask_b32_e64 v29, v29, 0, vcc
    v_cmp_eq_u32 vcc, v20, v30
    s_nop 1
    v_cndmask_b32_e64 v30, v30, 0, vcc
    v_cmp_eq_u32 vcc, v20, v31
    s_nop 1
    v_cndmask_b32_e64 v31, v31, 0, vcc
    v_and_b32 v21, 2047, v20
    v_sub_u32 v21, 2047, v21
    s_nop 0
    v_readfirstlane_b32 s43, v21
    v_max3_u32 v20, v24, v25, v26
    v_max3_u32 v20, v20, v27, v28
    v_max3_u32 v20, v20, v29, v30
    v_max_u32 v20, v20, v31
    s_nop 1
    v_max_u32_dpp v20, v20, v20 quad_perm:[1,0,3,2] row_mask:0xf bank_mask:0xf
    s_nop 1
    v_max_u32_dpp v20, v20, v20 quad_perm:[2,3,0,1] row_mask:0xf bank_mask:0xf
    s_nop 1
    v_max_u32_dpp v20, v20, v20 row_half_mirror row_mask:0xf bank_mask:0xf
    s_nop 1
    v_max_u32_dpp v20, v20, v20 row_mirror row_mask:0xf bank_mask:0xf
    s_nop 1
    v_max_u32_dpp v20, v20, v20 row_bcast:15 row_mask:0xa bank_mask:0xf
    s_nop 1
    v_max_u32_dpp v20, v20, v20 row_bcast:31 row_mask:0xc bank_mask:0xf
    s_nop 0
    v_readlane_b32 s20, v20, 63
    s_nop 1
    v_mov_b32 v20, s20
    v_lshlrev_b32 v21, 2, v4
    ds_write_b32 v21, v20 offset:64
    s_waitcnt lgkmcnt(0)
    s_barrier
    v_mov_b32 v21, 0
    ds_read_b128 v[32:35], v21 offset:64
    s_waitcnt lgkmcnt(0)
    v_max3_u32 v20, v32, v33, v34
    v_max_u32 v20, v20, v35
    v_cmp_eq_u32 vcc, v20, v24
    s_nop 1
    v_cndmask_b32_e64 v24, v24, 0, vcc
    v_cmp_eq_u32 vcc, v20, v25
    s_nop 1
    v_cndmask_b32_e64 v25, v25, 0, vcc
    v_cmp_eq_u32 vcc, v20, v26
    s_nop 1
    v_cndmask_b32_e64 v26, v26, 0, vcc
    v_cmp_eq_u32 vcc, v20, v27
    s_nop 1
    v_cndmask_b32_e64 v27, v27, 0, vcc
    v_cmp_eq_u32 vcc, v20, v28
    s_nop 1
    v_cndmask_b32_e64 v28, v28, 0, vcc
    v_cmp_eq_u32 vcc, v20, v29
    s_nop 1
    v_cndmask_b32_e64 v29, v29, 0, vcc
    v_cmp_eq_u32 vcc, v20, v30
    s_nop 1
    v_cndmask_b32_e64 v30, v30, 0, vcc
    v_cmp_eq_u32 vcc, v20, v31
    s_nop 1
    v_cndmask_b32_e64 v31, v31, 0, vcc
    v_and_b32 v21, 2047, v20
    v_sub_u32 v21, 2047, v21
    s_nop 0
    v_readfirstlane_b32 s44, v21
    v_max3_u32 v20, v24, v25, v26
    v_max3_u32 v20, v20, v27, v28
    v_max3_u32 v20, v20, v29, v30
    v_max_u32 v20, v20, v31
    s_nop 1
    v_max_u32_dpp v20, v20, v20 quad_perm:[1,0,3,2] row_mask:0xf bank_mask:0xf
    s_nop 1
    v_max_u32_dpp v20, v20, v20 quad_perm:[2,3,0,1] row_mask:0xf bank_mask:0xf
    s_nop 1
    v_max_u32_dpp v20, v20, v20 row_half_mirror row_mask:0xf bank_mask:0xf
    s_nop 1
    v_max_u32_dpp v20, v20, v20 row_mirror row_mask:0xf bank_mask:0xf
    s_nop 1
    v_max_u32_dpp v20, v20, v20 row_bcast:15 row_mask:0xa bank_mask:0xf
    s_nop 1
    v_max_u32_dpp v20, v20, v20 row_bcast:31 row_mask:0xc bank_mask:0xf
    s_nop 0
    v_readlane_b32 s20, v20, 63
    s_nop 1
    v_mov_b32 v20, s20
    v_lshlrev_b32 v21, 2, v4
    ds_write_b32 v21, v20 offset:80
    s_waitcnt lgkmcnt(0)
    s_barrier
    v_mov_b32 v21, 0
    ds_read_b128 v[32:35], v21 offset:80
    s_waitcnt lgkmcnt(0)
    v_max3_u32 v20, v32, v33, v34
    v_max_u32 v20, v20, v35
    v_cmp_eq_u32 vcc, v20, v24
    s_nop 1
    v_cndmask_b32_e64 v24, v24, 0, vcc
    v_cmp_eq_u32 vcc, v20, v25
    s_nop 1
    v_cndmask_b32_e64 v25, v25, 0, vcc
    v_cmp_eq_u32 vcc, v20, v26
    s_nop 1
    v_cndmask_b32_e64 v26, v26, 0, vcc
    v_cmp_eq_u32 vcc, v20, v27
    s_nop 1
    v_cndmask_b32_e64 v27, v27, 0, vcc
    v_cmp_eq_u32 vcc, v20, v28
    s_nop 1
    v_cndmask_b32_e64 v28, v28, 0, vcc
    v_cmp_eq_u32 vcc, v20, v29
    s_nop 1
    v_cndmask_b32_e64 v29, v29, 0, vcc
    v_cmp_eq_u32 vcc, v20, v30
    s_nop 1
    v_cndmask_b32_e64 v30, v30, 0, vcc
    v_cmp_eq_u32 vcc, v20, v31
    s_nop 1
    v_cndmask_b32_e64 v31, v31, 0, vcc
    v_and_b32 v21, 2047, v20
    v_sub_u32 v21, 2047, v21
    s_nop 0
    v_readfirstlane_b32 s45, v21
    v_max3_u32 v20, v24, v25, v26
    v_max3_u32 v20, v20, v27, v28
    v_max3_u32 v20, v20, v29, v30
    v_max_u32 v20, v20, v31
    s_nop 1
    v_max_u32_dpp v20, v20, v20 quad_perm:[1,0,3,2] row_mask:0xf bank_mask:0xf
    s_nop 1
    v_max_u32_dpp v20, v20, v20 quad_perm:[2,3,0,1] row_mask:0xf bank_mask:0xf
    s_nop 1
    v_max_u32_dpp v20, v20, v20 row_half_mirror row_mask:0xf bank_mask:0xf
    s_nop 1
    v_max_u32_dpp v20, v20, v20 row_mirror row_mask:0xf bank_mask:0xf
    s_nop 1
    v_max_u32_dpp v20, v20, v20 row_bcast:15 row_mask:0xa bank_mask:0xf
    s_nop 1
    v_max_u32_dpp v20, v20, v20 row_bcast:31 row_mask:0xc bank_mask:0xf
    s_nop 0
    v_readlane_b32 s20, v20, 63
    s_nop 1
    v_mov_b32 v20, s20
    v_lshlrev_b32 v21, 2, v4
    ds_write_b32 v21, v20 offset:96
    s_waitcnt lgkmcnt(0)
    s_barrier
    v_mov_b32 v21, 0
    ds_read_b128 v[32:35], v21 offset:96
    s_waitcnt lgkmcnt(0)
    v_max3_u32 v20, v32, v33, v34
    v_max_u32 v20, v20, v35
    v_cmp_eq_u32 vcc, v20, v24
    s_nop 1
    v_cndmask_b32_e64 v24, v24, 0, vcc
    v_cmp_eq_u32 vcc, v20, v25
    s_nop 1
    v_cndmask_b32_e64 v25, v25, 0, vcc
    v_cmp_eq_u32 vcc, v20, v26
    s_nop 1
    v_cndmask_b32_e64 v26, v26, 0, vcc
    v_cmp_eq_u32 vcc, v20, v27
    s_nop 1
    v_cndmask_b32_e64 v27, v27, 0, vcc
    v_cmp_eq_u32 vcc, v20, v28
    s_nop 1
    v_cndmask_b32_e64 v28, v28, 0, vcc
    v_cmp_eq_u32 vcc, v20, v29
    s_nop 1
    v_cndmask_b32_e64 v29, v29, 0, vcc
    v_cmp_eq_u32 vcc, v20, v30
    s_nop 1
    v_cndmask_b32_e64 v30, v30, 0, vcc
    v_cmp_eq_u32 vcc, v20, v31
    s_nop 1
    v_cndmask_b32_e64 v31, v31, 0, vcc
    v_and_b32 v21, 2047, v20
    v_sub_u32 v21, 2047, v21
    s_nop 0
    v_readfirstlane_b32 s46, v21
    v_max3_u32 v20, v24, v25, v26
    v_max3_u32 v20, v20, v27, v28
    v_max3_u32 v20, v20, v29, v30
    v_max_u32 v20, v20, v31
    s_nop 1
    v_max_u32_dpp v20, v20, v20 quad_perm:[1,0,3,2] row_mask:0xf bank_mask:0xf
    s_nop 1
    v_max_u32_dpp v20, v20, v20 quad_perm:[2,3,0,1] row_mask:0xf bank_mask:0xf
    s_nop 1
    v_max_u32_dpp v20, v20, v20 row_half_mirror row_mask:0xf bank_mask:0xf
    s_nop 1
    v_max_u32_dpp v20, v20, v20 row_mirror row_mask:0xf bank_mask:0xf
    s_nop 1
    v_max_u32_dpp v20, v20, v20 row_bcast:15 row_mask:0xa bank_mask:0xf
    s_nop 1
    v_max_u32_dpp v20, v20, v20 row_bcast:31 row_mask:0xc bank_mask:0xf
    s_nop 0
    v_readlane_b32 s20, v20, 63
    s_nop 1
    v_mov_b32 v20, s20
    v_lshlrev_b32 v21, 2, v4
    ds_write_b32 v21, v20 offset:112
    s_waitcnt lgkmcnt(0)
    s_barrier
    v_mov_b32 v21, 0
    ds_read_b128 v[32:35], v21 offset:112
    s_waitcnt lgkmcnt(0)
    v_max3_u32 v20, v32, v33, v34
    v_max_u32 v20, v20, v35
    v_cmp_eq_u32 vcc, v20, v24
    s_nop 1
    v_cndmask_b32_e64 v24, v24, 0, vcc
    v_cmp_eq_u32 vcc, v20, v25
    s_nop 1
    v_cndmask_b32_e64 v25, v25, 0, vcc
    v_cmp_eq_u32 vcc, v20, v26
    s_nop 1
    v_cndmask_b32_e64 v26, v26, 0, vcc
    v_cmp_eq_u32 vcc, v20, v27
    s_nop 1
    v_cndmask_b32_e64 v27, v27, 0, vcc
    v_cmp_eq_u32 vcc, v20, v28
    s_nop 1
    v_cndmask_b32_e64 v28, v28, 0, vcc
    v_cmp_eq_u32 vcc, v20, v29
    s_nop 1
    v_cndmask_b32_e64 v29, v29, 0, vcc
    v_cmp_eq_u32 vcc, v20, v30
    s_nop 1
    v_cndmask_b32_e64 v30, v30, 0, vcc
    v_cmp_eq_u32 vcc, v20, v31
    s_nop 1
    v_cndmask_b32_e64 v31, v31, 0, vcc
    v_and_b32 v21, 2047, v20
    v_sub_u32 v21, 2047, v21
    s_nop 0
    v_readfirstlane_b32 s47, v21
    v_and_b32 v20, 7, v1
    v_mov_b32 v21, s40
    v_cmp_eq_u32 vcc, 1, v20
    v_mov_b32 v22, s41
    s_nop 0
    v_cndmask_b32 v21, v21, v22, vcc
    v_cmp_eq_u32 vcc, 2, v20
    v_mov_b32 v22, s42
    s_nop 0
    v_cndmask_b32 v21, v21, v22, vcc
    v_cmp_eq_u32 vcc, 3, v20
    v_mov_b32 v22, s43
    s_nop 0
    v_cndmask_b32 v21, v21, v22, vcc
    v_cmp_eq_u32 vcc, 4, v20
    v_mov_b32 v22, s44
    s_nop 0
    v_cndmask_b32 v21, v21, v22, vcc
    v_cmp_eq_u32 vcc, 5, v20
    v_mov_b32 v22, s45
    s_nop 0
    v_cndmask_b32 v21, v21, v22, vcc
    v_cmp_eq_u32 vcc, 6, v20
    v_mov_b32 v22, s46
    s_nop 0
    v_cndmask_b32 v21, v21, v22, vcc
    v_cmp_eq_u32 vcc, 7, v20
    v_mov_b32 v22, s47
    s_nop 0
    v_cndmask_b32 v21, v21, v22, vcc
    v_mul_u32_u24 v21, 1280, v21
    v_mul_u32_u24 v22, 320, v4
    v_add_u32 v21, v21, v22
    v_lshl_add_u32 v21, v3, 4, v21
    s_mov_b32 s20, 0x1800000
    buffer_load_dwordx4 v[104:107], v21, s[16:19], s20 offen offset:0
    buffer_load_dwordx4 v[108:111], v21, s[16:19], s20 offen offset:64
    buffer_load_dwordx4 v[112:115], v21, s[16:19], s20 offen offset:128
    buffer_load_dwordx4 v[116:119], v21, s[16:19], s20 offen offset:192
    buffer_load_dwordx4 v[120:123], v21, s[16:19], s20 offen offset:256
    v_mov_b32 v40, 0
    v_mov_b32 v41, 0
    v_mov_b32 v42, 0
    v_mov_b32 v43, 0
    v_mov_b32 v44, 0
    v_mov_b32 v45, 0
    v_mov_b32 v46, 0
    v_mov_b32 v47, 0
    s_waitcnt vmcnt(0)
    v_lshl_or_b32 v64, v129, 16, v128
    v_lshl_or_b32 v84, v169, 16, v168
    v_lshl_or_b32 v65, v131, 16, v130
    v_lshl_or_b32 v85, v171, 16, v170
    v_lshl_or_b32 v66, v133, 16, v132
    v_lshl_or_b32 v86, v173, 16, v172
    v_lshl_or_b32 v67, v135, 16, v134
    v_lshl_or_b32 v87, v175, 16, v174
    v_lshl_or_b32 v68, v137, 16, v136
    v_lshl_or_b32 v88, v177, 16, v176
    v_lshl_or_b32 v69, v139, 16, v138
    v_lshl_or_b32 v89, v179, 16, v178
    v_lshl_or_b32 v70, v141, 16, v140
    v_lshl_or_b32 v90, v181, 16, v180
    v_lshl_or_b32 v71, v143, 16, v142
    v_lshl_or_b32 v91, v183, 16, v182
    v_lshl_or_b32 v72, v145, 16, v144
    v_lshl_or_b32 v92, v185, 16, v184
    v_lshl_or_b32 v73, v147, 16, v146
    v_lshl_or_b32 v93, v187, 16, v186
    v_lshl_or_b32 v74, v149, 16, v148
    v_lshl_or_b32 v94, v189, 16, v188
    v_lshl_or_b32 v75, v151, 16, v150
    v_lshl_or_b32 v95, v191, 16, v190
    v_lshl_or_b32 v76, v153, 16, v152
    v_lshl_or_b32 v96, v193, 16, v192
    v_lshl_or_b32 v77, v155, 16, v154
    v_lshl_or_b32 v97, v195, 16, v194
    v_lshl_or_b32 v78, v157, 16, v156
    v_lshl_or_b32 v98, v197, 16, v196
    v_lshl_or_b32 v79, v159, 16, v158
    v_lshl_or_b32 v99, v199, 16, v198
    v_lshl_or_b32 v80, v161, 16, v160
    v_lshl_or_b32 v100, v201, 16, v200
    v_lshl_or_b32 v81, v163, 16, v162
    v_lshl_or_b32 v101, v203, 16, v202
    v_lshl_or_b32 v82, v165, 16, v164
    v_lshl_or_b32 v102, v205, 16, v204
    v_lshl_or_b32 v83, v167, 16, v166
    v_lshl_or_b32 v103, v207, 16, v206
    ds_write_b128 v7, v[208:211] offset:9216
    ds_write_b128 v7, v[212:215] offset:13312
    ds_write_b128 v7, v[216:219] offset:17408
    ds_write_b128 v7, v[220:223] offset:21504
    ds_write_b128 v7, v[224:227] offset:25600
    v_mfma_f32_16x16x32_bf16 v[40:43], v[104:107], v[64:67], v[40:43]
    v_mfma_f32_16x16x32_bf16 v[44:47], v[104:107], v[84:87], v[44:47]
    v_mfma_f32_16x16x32_bf16 v[40:43], v[108:111], v[68:71], v[40:43]
    v_mfma_f32_16x16x32_bf16 v[44:47], v[108:111], v[88:91], v[44:47]
    v_mfma_f32_16x16x32_bf16 v[40:43], v[112:115], v[72:75], v[40:43]
    v_mfma_f32_16x16x32_bf16 v[44:47], v[112:115], v[92:95], v[44:47]
    v_mfma_f32_16x16x32_bf16 v[40:43], v[116:119], v[76:79], v[40:43]
    v_mfma_f32_16x16x32_bf16 v[44:47], v[116:119], v[96:99], v[44:47]
    v_mfma_f32_16x16x32_bf16 v[40:43], v[120:123], v[80:83], v[40:43]
    v_mfma_f32_16x16x32_bf16 v[44:47], v[120:123], v[100:103], v[44:47]
    s_nop 7
    s_nop 1
    v_lshlrev_b32 v20, 4, v1
    v_lshl_add_u32 v20, v4, 11, v20
    ds_write_b128 v20, v[40:43] offset:256
    ds_write_b128 v20, v[44:47] offset:1280
    s_waitcnt lgkmcnt(0)
    s_barrier
    v_cmp_gt_u32 vcc, 32, v0
    s_and_saveexec_b64 s[22:23], vcc
    s_cbranch_execz ffn1_kernel_p2
    v_lshlrev_b32 v20, 4, v1
    ds_read_b128 v[48:51], v20 offset:2304
    ds_read_b128 v[52:55], v20 offset:3328
    s_waitcnt lgkmcnt(0)
    v_add_f32 v40, v40, v48
    v_add_f32 v41, v41, v49
    v_add_f32 v42, v42, v50
    v_add_f32 v43, v43, v51
    v_add_f32 v44, v44, v52
    v_add_f32 v45, v45, v53
    v_add_f32 v46, v46, v54
    v_add_f32 v47, v47, v55
    ds_read_b128 v[48:51], v20 offset:4352
    ds_read_b128 v[52:55], v20 offset:5376
    s_waitcnt lgkmcnt(0)
    v_add_f32 v40, v40, v48
    v_add_f32 v41, v41, v49
    v_add_f32 v42, v42, v50
    v_add_f32 v43, v43, v51
    v_add_f32 v44, v44, v52
    v_add_f32 v45, v45, v53
    v_add_f32 v46, v46, v54
    v_add_f32 v47, v47, v55
    ds_read_b128 v[48:51], v20 offset:6400
    ds_read_b128 v[52:55], v20 offset:7424
    s_waitcnt lgkmcnt(0)
    v_add_f32 v40, v40, v48
    v_add_f32 v41, v41, v49
    v_add_f32 v42, v42, v50
    v_add_f32 v43, v43, v51
    v_add_f32 v44, v44, v52
    v_add_f32 v45, v45, v53
    v_add_f32 v46, v46, v54
    v_add_f32 v47, v47, v55
    v_lshlrev_b32 v21, 7, v3
    v_lshl_add_u32 v21, v2, 1, v21
    v_cvt_pk_bf16_f32 v40, v40, v40
    v_lshlrev_b32 v40, 16, v40
    v_cvt_pk_bf16_f32 v44, v44, v44
    v_lshlrev_b32 v44, 16, v44
    v_mul_f32 v48, 0xbfb8aa3b, v40
    v_exp_f32 v48, v48
    s_nop 0
    v_add_f32 v48, 1.0, v48
    v_rcp_f32 v48, v48
    s_nop 0
    v_mul_f32 v48, v48, v40
    v_cvt_pk_bf16_f32 v48, v48, v48
    v_lshlrev_b32 v48, 16, v48
    v_mul_f32 v48, v48, v44
    v_cvt_pk_bf16_f32 v48, v48, v48
    ds_write_b16 v21, v48 offset:8704
    v_cvt_pk_bf16_f32 v41, v41, v41
    v_lshlrev_b32 v41, 16, v41
    v_cvt_pk_bf16_f32 v45, v45, v45
    v_lshlrev_b32 v45, 16, v45
    v_mul_f32 v48, 0xbfb8aa3b, v41
    v_exp_f32 v48, v48
    s_nop 0
    v_add_f32 v48, 1.0, v48
    v_rcp_f32 v48, v48
    s_nop 0
    v_mul_f32 v48, v48, v41
    v_cvt_pk_bf16_f32 v48, v48, v48
    v_lshlrev_b32 v48, 16, v48
    v_mul_f32 v48, v48, v45
    v_cvt_pk_bf16_f32 v48, v48, v48
    ds_write_b16 v21, v48 offset:8736
    v_cvt_pk_bf16_f32 v42, v42, v42
    v_lshlrev_b32 v42, 16, v42
    v_cvt_pk_bf16_f32 v46, v46, v46
    v_lshlrev_b32 v46, 16, v46
    v_mul_f32 v48, 0xbfb8aa3b, v42
    v_exp_f32 v48, v48
    s_nop 0
    v_add_f32 v48, 1.0, v48
    v_rcp_f32 v48, v48
    s_nop 0
    v_mul_f32 v48, v48, v42
    v_cvt_pk_bf16_f32 v48, v48, v48
    v_lshlrev_b32 v48, 16, v48
    v_mul_f32 v48, v48, v46
    v_cvt_pk_bf16_f32 v48, v48, v48
    ds_write_b16 v21, v48 offset:8768
    v_cvt_pk_bf16_f32 v43, v43, v43
    v_lshlrev_b32 v43, 16, v43
    v_cvt_pk_bf16_f32 v47, v47, v47
    v_lshlrev_b32 v47, 16, v47
    v_mul_f32 v48, 0xbfb8aa3b, v43
    v_exp_f32 v48, v48
    s_nop 0
    v_add_f32 v48, 1.0, v48
    v_rcp_f32 v48, v48
    s_nop 0
    v_mul_f32 v48, v48, v43
    v_cvt_pk_bf16_f32 v48, v48, v48
    v_lshlrev_b32 v48, 16, v48
    v_mul_f32 v48, v48, v47
    v_cvt_pk_bf16_f32 v48, v48, v48
    ds_write_b16 v21, v48 offset:8800
ffn1_kernel_p2:
    s_mov_b64 exec, s[22:23]
    s_waitcnt lgkmcnt(0)
    s_barrier
    v_and_b32 v20, 7, v1
    v_lshlrev_b32 v20, 5, v20
    v_and_b32 v22, 1, v3
    v_lshl_add_u32 v20, v22, 4, v20
    ds_read_b128 v[64:67], v20 offset:8704
    v_mul_u32_u24 v21, 10240, v22
    v_lshl_add_u32 v21, v2, 1, v21
    v_mul_u32_u24 v23, 320, v4
    v_add_u32 v21, v21, v23
    ds_read_u16 v128, v21 offset:9216
    ds_read_u16 v129, v21 offset:10496
    ds_read_u16 v130, v21 offset:11776
    ds_read_u16 v131, v21 offset:13056
    ds_read_u16 v132, v21 offset:14336
    ds_read_u16 v133, v21 offset:15616
    ds_read_u16 v134, v21 offset:16896
    ds_read_u16 v135, v21 offset:18176
    ds_read_u16 v136, v21 offset:9248
    ds_read_u16 v137, v21 offset:10528
    ds_read_u16 v138, v21 offset:11808
    ds_read_u16 v139, v21 offset:13088
    ds_read_u16 v140, v21 offset:14368
    ds_read_u16 v141, v21 offset:15648
    ds_read_u16 v142, v21 offset:16928
    ds_read_u16 v143, v21 offset:18208
    ds_read_u16 v144, v21 offset:9280
    ds_read_u16 v145, v21 offset:10560
    ds_read_u16 v146, v21 offset:11840
    ds_read_u16 v147, v21 offset:13120
    ds_read_u16 v148, v21 offset:14400
    ds_read_u16 v149, v21 offset:15680
    ds_read_u16 v150, v21 offset:16960
    ds_read_u16 v151, v21 offset:18240
    ds_read_u16 v152, v21 offset:9312
    ds_read_u16 v153, v21 offset:10592
    ds_read_u16 v154, v21 offset:11872
    ds_read_u16 v155, v21 offset:13152
    ds_read_u16 v156, v21 offset:14432
    ds_read_u16 v157, v21 offset:15712
    ds_read_u16 v158, v21 offset:16992
    ds_read_u16 v159, v21 offset:18272
    ds_read_u16 v160, v21 offset:9344
    ds_read_u16 v161, v21 offset:10624
    ds_read_u16 v162, v21 offset:11904
    ds_read_u16 v163, v21 offset:13184
    ds_read_u16 v164, v21 offset:14464
    ds_read_u16 v165, v21 offset:15744
    ds_read_u16 v166, v21 offset:17024
    ds_read_u16 v167, v21 offset:18304
    ds_read_u16 v168, v21 offset:9376
    ds_read_u16 v169, v21 offset:10656
    ds_read_u16 v170, v21 offset:11936
    ds_read_u16 v171, v21 offset:13216
    ds_read_u16 v172, v21 offset:14496
    ds_read_u16 v173, v21 offset:15776
    ds_read_u16 v174, v21 offset:17056
    ds_read_u16 v175, v21 offset:18336
    ds_read_u16 v176, v21 offset:9408
    ds_read_u16 v177, v21 offset:10688
    ds_read_u16 v178, v21 offset:11968
    ds_read_u16 v179, v21 offset:13248
    ds_read_u16 v180, v21 offset:14528
    ds_read_u16 v181, v21 offset:15808
    ds_read_u16 v182, v21 offset:17088
    ds_read_u16 v183, v21 offset:18368
    ds_read_u16 v184, v21 offset:9440
    ds_read_u16 v185, v21 offset:10720
    ds_read_u16 v186, v21 offset:12000
    ds_read_u16 v187, v21 offset:13280
    ds_read_u16 v188, v21 offset:14560
    ds_read_u16 v189, v21 offset:15840
    ds_read_u16 v190, v21 offset:17120
    ds_read_u16 v191, v21 offset:18400
    ds_read_u16 v192, v21 offset:9472
    ds_read_u16 v193, v21 offset:10752
    ds_read_u16 v194, v21 offset:12032
    ds_read_u16 v195, v21 offset:13312
    ds_read_u16 v196, v21 offset:14592
    ds_read_u16 v197, v21 offset:15872
    ds_read_u16 v198, v21 offset:17152
    ds_read_u16 v199, v21 offset:18432
    ds_read_u16 v200, v21 offset:9504
    ds_read_u16 v201, v21 offset:10784
    ds_read_u16 v202, v21 offset:12064
    ds_read_u16 v203, v21 offset:13344
    ds_read_u16 v204, v21 offset:14624
    ds_read_u16 v205, v21 offset:15904
    ds_read_u16 v206, v21 offset:17184
    ds_read_u16 v207, v21 offset:18464
    s_waitcnt lgkmcnt(0)
    v_cmp_gt_u32 vcc, 2, v3
    s_nop 1
    v_cndmask_b32_e64 v64, 0, v64, vcc
    v_cndmask_b32_e64 v65, 0, v65, vcc
    v_cndmask_b32_e64 v66, 0, v66, vcc
    v_cndmask_b32_e64 v67, 0, v67, vcc
    v_lshl_or_b32 v68, v129, 16, v128
    v_lshl_or_b32 v69, v131, 16, v130
    v_lshl_or_b32 v70, v133, 16, v132
    v_lshl_or_b32 v71, v135, 16, v134
    v_lshl_or_b32 v72, v137, 16, v136
    v_lshl_or_b32 v73, v139, 16, v138
    v_lshl_or_b32 v74, v141, 16, v140
    v_lshl_or_b32 v75, v143, 16, v142
    v_lshl_or_b32 v76, v145, 16, v144
    v_lshl_or_b32 v77, v147, 16, v146
    v_lshl_or_b32 v78, v149, 16, v148
    v_lshl_or_b32 v79, v151, 16, v150
    v_lshl_or_b32 v80, v153, 16, v152
    v_lshl_or_b32 v81, v155, 16, v154
    v_lshl_or_b32 v82, v157, 16, v156
    v_lshl_or_b32 v83, v159, 16, v158
    v_lshl_or_b32 v84, v161, 16, v160
    v_lshl_or_b32 v85, v163, 16, v162
    v_lshl_or_b32 v86, v165, 16, v164
    v_lshl_or_b32 v87, v167, 16, v166
    v_lshl_or_b32 v88, v169, 16, v168
    v_lshl_or_b32 v89, v171, 16, v170
    v_lshl_or_b32 v90, v173, 16, v172
    v_lshl_or_b32 v91, v175, 16, v174
    v_lshl_or_b32 v92, v177, 16, v176
    v_lshl_or_b32 v93, v179, 16, v178
    v_lshl_or_b32 v94, v181, 16, v180
    v_lshl_or_b32 v95, v183, 16, v182
    v_lshl_or_b32 v96, v185, 16, v184
    v_lshl_or_b32 v97, v187, 16, v186
    v_lshl_or_b32 v98, v189, 16, v188
    v_lshl_or_b32 v99, v191, 16, v190
    v_lshl_or_b32 v100, v193, 16, v192
    v_lshl_or_b32 v101, v195, 16, v194
    v_lshl_or_b32 v102, v197, 16, v196
    v_lshl_or_b32 v103, v199, 16, v198
    v_lshl_or_b32 v104, v201, 16, v200
    v_lshl_or_b32 v105, v203, 16, v202
    v_lshl_or_b32 v106, v205, 16, v204
    v_lshl_or_b32 v107, v207, 16, v206
    s_nop 1
    v_mfma_f32_16x16x32_bf16 v[128:131], v[64:67], v[68:71], 0
    v_mfma_f32_16x16x32_bf16 v[132:135], v[64:67], v[72:75], 0
    v_mfma_f32_16x16x32_bf16 v[136:139], v[64:67], v[76:79], 0
    v_mfma_f32_16x16x32_bf16 v[140:143], v[64:67], v[80:83], 0
    v_mfma_f32_16x16x32_bf16 v[144:147], v[64:67], v[84:87], 0
    v_mfma_f32_16x16x32_bf16 v[148:151], v[64:67], v[88:91], 0
    v_mfma_f32_16x16x32_bf16 v[152:155], v[64:67], v[92:95], 0
    v_mfma_f32_16x16x32_bf16 v[156:159], v[64:67], v[96:99], 0
    v_mfma_f32_16x16x32_bf16 v[160:163], v[64:67], v[100:103], 0
    v_mfma_f32_16x16x32_bf16 v[164:167], v[64:67], v[104:107], 0
    s_nop 7
    s_nop 1
    v_mul_u32_u24 v20, 10240, v3
    v_lshl_add_u32 v20, v2, 2, v20
    v_mul_u32_u24 v23, 640, v4
    v_add_u32 v20, v20, v23
    s_and_saveexec_b64 s[22:23], vcc
    s_mov_b32 s20, 0x1c10000
    buffer_atomic_add_f32 v128, v20, s[16:19], s20 offen offset:0
    buffer_atomic_add_f32 v132, v20, s[16:19], s20 offen offset:64
    buffer_atomic_add_f32 v136, v20, s[16:19], s20 offen offset:128
    buffer_atomic_add_f32 v140, v20, s[16:19], s20 offen offset:192
    buffer_atomic_add_f32 v144, v20, s[16:19], s20 offen offset:256
    buffer_atomic_add_f32 v148, v20, s[16:19], s20 offen offset:320
    buffer_atomic_add_f32 v152, v20, s[16:19], s20 offen offset:384
    buffer_atomic_add_f32 v156, v20, s[16:19], s20 offen offset:448
    buffer_atomic_add_f32 v160, v20, s[16:19], s20 offen offset:512
    buffer_atomic_add_f32 v164, v20, s[16:19], s20 offen offset:576
    s_add_u32 s20, s20, 2560
    buffer_atomic_add_f32 v129, v20, s[16:19], s20 offen offset:0
    buffer_atomic_add_f32 v133, v20, s[16:19], s20 offen offset:64
    buffer_atomic_add_f32 v137, v20, s[16:19], s20 offen offset:128
    buffer_atomic_add_f32 v141, v20, s[16:19], s20 offen offset:192
    buffer_atomic_add_f32 v145, v20, s[16:19], s20 offen offset:256
    buffer_atomic_add_f32 v149, v20, s[16:19], s20 offen offset:320
    buffer_atomic_add_f32 v153, v20, s[16:19], s20 offen offset:384
    buffer_atomic_add_f32 v157, v20, s[16:19], s20 offen offset:448
    buffer_atomic_add_f32 v161, v20, s[16:19], s20 offen offset:512
    buffer_atomic_add_f32 v165, v20, s[16:19], s20 offen offset:576
    s_add_u32 s20, s20, 2560
    buffer_atomic_add_f32 v130, v20, s[16:19], s20 offen offset:0
    buffer_atomic_add_f32 v134, v20, s[16:19], s20 offen offset:64
    buffer_atomic_add_f32 v138, v20, s[16:19], s20 offen offset:128
    buffer_atomic_add_f32 v142, v20, s[16:19], s20 offen offset:192
    buffer_atomic_add_f32 v146, v20, s[16:19], s20 offen offset:256
    buffer_atomic_add_f32 v150, v20, s[16:19], s20 offen offset:320
    buffer_atomic_add_f32 v154, v20, s[16:19], s20 offen offset:384
    buffer_atomic_add_f32 v158, v20, s[16:19], s20 offen offset:448
    buffer_atomic_add_f32 v162, v20, s[16:19], s20 offen offset:512
    buffer_atomic_add_f32 v166, v20, s[16:19], s20 offen offset:576
    s_add_u32 s20, s20, 2560
    buffer_atomic_add_f32 v131, v20, s[16:19], s20 offen offset:0
    buffer_atomic_add_f32 v135, v20, s[16:19], s20 offen offset:64
    buffer_atomic_add_f32 v139, v20, s[16:19], s20 offen offset:128
    buffer_atomic_add_f32 v143, v20, s[16:19], s20 offen offset:192
    buffer_atomic_add_f32 v147, v20, s[16:19], s20 offen offset:256
    buffer_atomic_add_f32 v151, v20, s[16:19], s20 offen offset:320
    buffer_atomic_add_f32 v155, v20, s[16:19], s20 offen offset:384
    buffer_atomic_add_f32 v159, v20, s[16:19], s20 offen offset:448
    buffer_atomic_add_f32 v163, v20, s[16:19], s20 offen offset:512
    buffer_atomic_add_f32 v167, v20, s[16:19], s20 offen offset:576
    s_add_u32 s20, s20, 2560
    s_mov_b64 exec, s[22:23]
    s_waitcnt vmcnt(0)
    s_barrier
    v_cmp_eq_u32 vcc, 0, v0
    s_and_saveexec_b64 s[22:23], vcc
    s_cbranch_execz ffn1_kernel_cnt
    v_mov_b32 v20, 1
    v_mov_b32 v21, 0
    buffer_atomic_add v20, v21, s[64:67], 0 offen sc0
    s_waitcnt vmcnt(0)
    ds_write_b32 v21, v20 offset:128
ffn1_kernel_cnt:
    s_mov_b64 exec, s[22:23]
    s_waitcnt lgkmcnt(0)
    s_barrier
    v_mov_b32 v21, 0
    ds_read_b32 v20, v21 offset:128
    s_waitcnt lgkmcnt(0)
    v_readfirstlane_b32 s20, v20
    s_cmp_lg_u32 s20, 95
    s_cbranch_scc1 ffn1_kernel_done
    v_lshrrev_b32 v20, 5, v0
    v_mov_b32 v21, s40
    v_cmp_eq_u32 vcc, 1, v20
    v_mov_b32 v22, s41
    s_nop 0
    v_cndmask_b32 v21, v21, v22, vcc
    v_cmp_eq_u32 vcc, 2, v20
    v_mov_b32 v22, s42
    s_nop 0
    v_cndmask_b32 v21, v21, v22, vcc
    v_cmp_eq_u32 vcc, 3, v20
    v_mov_b32 v22, s43
    s_nop 0
    v_cndmask_b32 v21, v21, v22, vcc
    v_cmp_eq_u32 vcc, 4, v20
    v_mov_b32 v22, s44
    s_nop 0
    v_cndmask_b32 v21, v21, v22, vcc
    v_cmp_eq_u32 vcc, 5, v20
    v_mov_b32 v22, s45
    s_nop 0
    v_cndmask_b32 v21, v21, v22, vcc
    v_cmp_eq_u32 vcc, 6, v20
    v_mov_b32 v22, s46
    s_nop 0
    v_cndmask_b32 v21, v21, v22, vcc
    v_cmp_eq_u32 vcc, 7, v20
    v_mov_b32 v22, s47
    s_nop 0
    v_cndmask_b32 v21, v21, v22, vcc
    v_and_b32 v22, 31, v0
    v_mul_u32_u24 v23, 2560, v20
    v_lshl_add_u32 v23, v22, 2, v23
    v_mul_u32_u24 v24, 1280, v21
    v_lshl_add_u32 v24, v22, 1, v24
    v_lshlrev_b32 v25, 1, v21
    s_mov_b32 s20, 0x1c00000
    buffer_load_ushort v26, v25, s[16:19], s20 offen
    s_mov_b32 s20, 0x1c10000
    s_mov_b32 s21, 0x1400000
    s_mov_b32 s28, 0x1800000
    v_mov_b32 v64, 0
    v_mov_b32 v65, 0
    v_mov_b32 v66, 0
    v_mov_b32 v67, 0
    v_mov_b32 v68, 0
    v_mov_b32 v69, 0
    v_mov_b32 v70, 0
    v_mov_b32 v71, 0
    v_mov_b32 v72, 0
    v_mov_b32 v73, 0
    v_mov_b32 v74, 0
    v_mov_b32 v75, 0
    v_mov_b32 v76, 0
    v_mov_b32 v77, 0
    v_mov_b32 v78, 0
    v_mov_b32 v79, 0
    v_mov_b32 v80, 0
    v_mov_b32 v81, 0
    v_mov_b32 v82, 0
    v_mov_b32 v83, 0
    buffer_atomic_add_f32 v64, v23, s[16:19], s20 offen offset:0 sc0
    buffer_load_ushort v84, v24, s[16:19], s21 offen offset:0
    buffer_load_ushort v104, v24, s[16:19], s28 offen offset:0
    buffer_atomic_add_f32 v65, v23, s[16:19], s20 offen offset:128 sc0
    buffer_load_ushort v85, v24, s[16:19], s21 offen offset:64
    buffer_load_ushort v105, v24, s[16:19], s28 offen offset:64
    buffer_atomic_add_f32 v66, v23, s[16:19], s20 offen offset:256 sc0
    buffer_load_ushort v86, v24, s[16:19], s21 offen offset:128
    buffer_load_ushort v106, v24, s[16:19], s28 offen offset:128
    buffer_atomic_add_f32 v67, v23, s[16:19], s20 offen offset:384 sc0
    buffer_load_ushort v87, v24, s[16:19], s21 offen offset:192
    buffer_load_ushort v107, v24, s[16:19], s28 offen offset:192
    buffer_atomic_add_f32 v68, v23, s[16:19], s20 offen offset:512 sc0
    buffer_load_ushort v88, v24, s[16:19], s21 offen offset:256
    buffer_load_ushort v108, v24, s[16:19], s28 offen offset:256
    buffer_atomic_add_f32 v69, v23, s[16:19], s20 offen offset:640 sc0
    buffer_load_ushort v89, v24, s[16:19], s21 offen offset:320
    buffer_load_ushort v109, v24, s[16:19], s28 offen offset:320
    buffer_atomic_add_f32 v70, v23, s[16:19], s20 offen offset:768 sc0
    buffer_load_ushort v90, v24, s[16:19], s21 offen offset:384
    buffer_load_ushort v110, v24, s[16:19], s28 offen offset:384
    buffer_atomic_add_f32 v71, v23, s[16:19], s20 offen offset:896 sc0
    buffer_load_ushort v91, v24, s[16:19], s21 offen offset:448
    buffer_load_ushort v111, v24, s[16:19], s28 offen offset:448
    buffer_atomic_add_f32 v72, v23, s[16:19], s20 offen offset:1024 sc0
    buffer_load_ushort v92, v24, s[16:19], s21 offen offset:512
    buffer_load_ushort v112, v24, s[16:19], s28 offen offset:512
    buffer_atomic_add_f32 v73, v23, s[16:19], s20 offen offset:1152 sc0
    buffer_load_ushort v93, v24, s[16:19], s21 offen offset:576
    buffer_load_ushort v113, v24, s[16:19], s28 offen offset:576
    buffer_atomic_add_f32 v74, v23, s[16:19], s20 offen offset:1280 sc0
    buffer_load_ushort v94, v24, s[16:19], s21 offen offset:640
    buffer_load_ushort v114, v24, s[16:19], s28 offen offset:640
    buffer_atomic_add_f32 v75, v23, s[16:19], s20 offen offset:1408 sc0
    buffer_load_ushort v95, v24, s[16:19], s21 offen offset:704
    buffer_load_ushort v115, v24, s[16:19], s28 offen offset:704
    buffer_atomic_add_f32 v76, v23, s[16:19], s20 offen offset:1536 sc0
    buffer_load_ushort v96, v24, s[16:19], s21 offen offset:768
    buffer_load_ushort v116, v24, s[16:19], s28 offen offset:768
    buffer_atomic_add_f32 v77, v23, s[16:19], s20 offen offset:1664 sc0
    buffer_load_ushort v97, v24, s[16:19], s21 offen offset:832
    buffer_load_ushort v117, v24, s[16:19], s28 offen offset:832
    buffer_atomic_add_f32 v78, v23, s[16:19], s20 offen offset:1792 sc0
    buffer_load_ushort v98, v24, s[16:19], s21 offen offset:896
    buffer_load_ushort v118, v24, s[16:19], s28 offen offset:896
    buffer_atomic_add_f32 v79, v23, s[16:19], s20 offen offset:1920 sc0
    buffer_load_ushort v99, v24, s[16:19], s21 offen offset:960
    buffer_load_ushort v119, v24, s[16:19], s28 offen offset:960
    buffer_atomic_add_f32 v80, v23, s[16:19], s20 offen offset:2048 sc0
    buffer_load_ushort v100, v24, s[16:19], s21 offen offset:1024
    buffer_load_ushort v120, v24, s[16:19], s28 offen offset:1024
    buffer_atomic_add_f32 v81, v23, s[16:19], s20 offen offset:2176 sc0
    buffer_load_ushort v101, v24, s[16:19], s21 offen offset:1088
    buffer_load_ushort v121, v24, s[16:19], s28 offen offset:1088
    buffer_atomic_add_f32 v82, v23, s[16:19], s20 offen offset:2304 sc0
    buffer_load_ushort v102, v24, s[16:19], s21 offen offset:1152
    buffer_load_ushort v122, v24, s[16:19], s28 offen offset:1152
    buffer_atomic_add_f32 v83, v23, s[16:19], s20 offen offset:2432 sc0
    buffer_load_ushort v103, v24, s[16:19], s21 offen offset:1216
    buffer_load_ushort v123, v24, s[16:19], s28 offen offset:1216
    s_waitcnt vmcnt(0)
    v_lshlrev_b32 v26, 16, v26
    v_mul_f32 v26, 0xbfb8aa3b, v26
    v_exp_f32 v26, v26
    s_nop 0
    v_add_f32 v26, 1.0, v26
    v_rcp_f32 v26, v26
    s_nop 0
    v_cvt_pk_bf16_f32 v26, v26, v26
    v_lshlrev_b32 v26, 16, v26
    v_cvt_pk_bf16_f32 v64, v64, v64
    v_lshlrev_b32 v64, 16, v64
    v_mul_f32 v20, v26, v64
    v_cvt_pk_bf16_f32 v20, v20, v20
    v_lshlrev_b32 v20, 16, v20
    v_lshlrev_b32 v21, 16, v104
    v_add_f32 v20, v20, v21
    v_cvt_pk_bf16_f32 v20, v20, v20
    v_lshlrev_b32 v20, 16, v20
    v_lshlrev_b32 v21, 16, v84
    v_add_f32 v20, v20, v21
    v_cvt_pk_bf16_f32 v64, v20, v20
    buffer_store_short v64, v24, s[60:63], 0 offen offset:0
    v_cvt_pk_bf16_f32 v65, v65, v65
    v_lshlrev_b32 v65, 16, v65
    v_mul_f32 v20, v26, v65
    v_cvt_pk_bf16_f32 v20, v20, v20
    v_lshlrev_b32 v20, 16, v20
    v_lshlrev_b32 v21, 16, v105
    v_add_f32 v20, v20, v21
    v_cvt_pk_bf16_f32 v20, v20, v20
    v_lshlrev_b32 v20, 16, v20
    v_lshlrev_b32 v21, 16, v85
    v_add_f32 v20, v20, v21
    v_cvt_pk_bf16_f32 v65, v20, v20
    buffer_store_short v65, v24, s[60:63], 0 offen offset:64
    v_cvt_pk_bf16_f32 v66, v66, v66
    v_lshlrev_b32 v66, 16, v66
    v_mul_f32 v20, v26, v66
    v_cvt_pk_bf16_f32 v20, v20, v20
    v_lshlrev_b32 v20, 16, v20
    v_lshlrev_b32 v21, 16, v106
    v_add_f32 v20, v20, v21
    v_cvt_pk_bf16_f32 v20, v20, v20
    v_lshlrev_b32 v20, 16, v20
    v_lshlrev_b32 v21, 16, v86
    v_add_f32 v20, v20, v21
    v_cvt_pk_bf16_f32 v66, v20, v20
    buffer_store_short v66, v24, s[60:63], 0 offen offset:128
    v_cvt_pk_bf16_f32 v67, v67, v67
    v_lshlrev_b32 v67, 16, v67
    v_mul_f32 v20, v26, v67
    v_cvt_pk_bf16_f32 v20, v20, v20
    v_lshlrev_b32 v20, 16, v20
    v_lshlrev_b32 v21, 16, v107
    v_add_f32 v20, v20, v21
    v_cvt_pk_bf16_f32 v20, v20, v20
    v_lshlrev_b32 v20, 16, v20
    v_lshlrev_b32 v21, 16, v87
    v_add_f32 v20, v20, v21
    v_cvt_pk_bf16_f32 v67, v20, v20
    buffer_store_short v67, v24, s[60:63], 0 offen offset:192
    v_cvt_pk_bf16_f32 v68, v68, v68
    v_lshlrev_b32 v68, 16, v68
    v_mul_f32 v20, v26, v68
    v_cvt_pk_bf16_f32 v20, v20, v20
    v_lshlrev_b32 v20, 16, v20
    v_lshlrev_b32 v21, 16, v108
    v_add_f32 v20, v20, v21
    v_cvt_pk_bf16_f32 v20, v20, v20
    v_lshlrev_b32 v20, 16, v20
    v_lshlrev_b32 v21, 16, v88
    v_add_f32 v20, v20, v21
    v_cvt_pk_bf16_f32 v68, v20, v20
    buffer_store_short v68, v24, s[60:63], 0 offen offset:256
    v_cvt_pk_bf16_f32 v69, v69, v69
    v_lshlrev_b32 v69, 16, v69
    v_mul_f32 v20, v26, v69
    v_cvt_pk_bf16_f32 v20, v20, v20
    v_lshlrev_b32 v20, 16, v20
    v_lshlrev_b32 v21, 16, v109
    v_add_f32 v20, v20, v21
    v_cvt_pk_bf16_f32 v20, v20, v20
    v_lshlrev_b32 v20, 16, v20
    v_lshlrev_b32 v21, 16, v89
    v_add_f32 v20, v20, v21
    v_cvt_pk_bf16_f32 v69, v20, v20
    buffer_store_short v69, v24, s[60:63], 0 offen offset:320
    v_cvt_pk_bf16_f32 v70, v70, v70
    v_lshlrev_b32 v70, 16, v70
    v_mul_f32 v20, v26, v70
    v_cvt_pk_bf16_f32 v20, v20, v20
    v_lshlrev_b32 v20, 16, v20
    v_lshlrev_b32 v21, 16, v110
    v_add_f32 v20, v20, v21
    v_cvt_pk_bf16_f32 v20, v20, v20
    v_lshlrev_b32 v20, 16, v20
    v_lshlrev_b32 v21, 16, v90
    v_add_f32 v20, v20, v21
    v_cvt_pk_bf16_f32 v70, v20, v20
    buffer_store_short v70, v24, s[60:63], 0 offen offset:384
    v_cvt_pk_bf16_f32 v71, v71, v71
    v_lshlrev_b32 v71, 16, v71
    v_mul_f32 v20, v26, v71
    v_cvt_pk_bf16_f32 v20, v20, v20
    v_lshlrev_b32 v20, 16, v20
    v_lshlrev_b32 v21, 16, v111
    v_add_f32 v20, v20, v21
    v_cvt_pk_bf16_f32 v20, v20, v20
    v_lshlrev_b32 v20, 16, v20
    v_lshlrev_b32 v21, 16, v91
    v_add_f32 v20, v20, v21
    v_cvt_pk_bf16_f32 v71, v20, v20
    buffer_store_short v71, v24, s[60:63], 0 offen offset:448
    v_cvt_pk_bf16_f32 v72, v72, v72
    v_lshlrev_b32 v72, 16, v72
    v_mul_f32 v20, v26, v72
    v_cvt_pk_bf16_f32 v20, v20, v20
    v_lshlrev_b32 v20, 16, v20
    v_lshlrev_b32 v21, 16, v112
    v_add_f32 v20, v20, v21
    v_cvt_pk_bf16_f32 v20, v20, v20
    v_lshlrev_b32 v20, 16, v20
    v_lshlrev_b32 v21, 16, v92
    v_add_f32 v20, v20, v21
    v_cvt_pk_bf16_f32 v72, v20, v20
    buffer_store_short v72, v24, s[60:63], 0 offen offset:512
    v_cvt_pk_bf16_f32 v73, v73, v73
    v_lshlrev_b32 v73, 16, v73
    v_mul_f32 v20, v26, v73
    v_cvt_pk_bf16_f32 v20, v20, v20
    v_lshlrev_b32 v20, 16, v20
    v_lshlrev_b32 v21, 16, v113
    v_add_f32 v20, v20, v21
    v_cvt_pk_bf16_f32 v20, v20, v20
    v_lshlrev_b32 v20, 16, v20
    v_lshlrev_b32 v21, 16, v93
    v_add_f32 v20, v20, v21
    v_cvt_pk_bf16_f32 v73, v20, v20
    buffer_store_short v73, v24, s[60:63], 0 offen offset:576
    v_cvt_pk_bf16_f32 v74, v74, v74
    v_lshlrev_b32 v74, 16, v74
    v_mul_f32 v20, v26, v74
    v_cvt_pk_bf16_f32 v20, v20, v20
    v_lshlrev_b32 v20, 16, v20
    v_lshlrev_b32 v21, 16, v114
    v_add_f32 v20, v20, v21
    v_cvt_pk_bf16_f32 v20, v20, v20
    v_lshlrev_b32 v20, 16, v20
    v_lshlrev_b32 v21, 16, v94
    v_add_f32 v20, v20, v21
    v_cvt_pk_bf16_f32 v74, v20, v20
    buffer_store_short v74, v24, s[60:63], 0 offen offset:640
    v_cvt_pk_bf16_f32 v75, v75, v75
    v_lshlrev_b32 v75, 16, v75
    v_mul_f32 v20, v26, v75
    v_cvt_pk_bf16_f32 v20, v20, v20
    v_lshlrev_b32 v20, 16, v20
    v_lshlrev_b32 v21, 16, v115
    v_add_f32 v20, v20, v21
    v_cvt_pk_bf16_f32 v20, v20, v20
    v_lshlrev_b32 v20, 16, v20
    v_lshlrev_b32 v21, 16, v95
    v_add_f32 v20, v20, v21
    v_cvt_pk_bf16_f32 v75, v20, v20
    buffer_store_short v75, v24, s[60:63], 0 offen offset:704
    v_cvt_pk_bf16_f32 v76, v76, v76
    v_lshlrev_b32 v76, 16, v76
    v_mul_f32 v20, v26, v76
    v_cvt_pk_bf16_f32 v20, v20, v20
    v_lshlrev_b32 v20, 16, v20
    v_lshlrev_b32 v21, 16, v116
    v_add_f32 v20, v20, v21
    v_cvt_pk_bf16_f32 v20, v20, v20
    v_lshlrev_b32 v20, 16, v20
    v_lshlrev_b32 v21, 16, v96
    v_add_f32 v20, v20, v21
    v_cvt_pk_bf16_f32 v76, v20, v20
    buffer_store_short v76, v24, s[60:63], 0 offen offset:768
    v_cvt_pk_bf16_f32 v77, v77, v77
    v_lshlrev_b32 v77, 16, v77
    v_mul_f32 v20, v26, v77
    v_cvt_pk_bf16_f32 v20, v20, v20
    v_lshlrev_b32 v20, 16, v20
    v_lshlrev_b32 v21, 16, v117
    v_add_f32 v20, v20, v21
    v_cvt_pk_bf16_f32 v20, v20, v20
    v_lshlrev_b32 v20, 16, v20
    v_lshlrev_b32 v21, 16, v97
    v_add_f32 v20, v20, v21
    v_cvt_pk_bf16_f32 v77, v20, v20
    buffer_store_short v77, v24, s[60:63], 0 offen offset:832
    v_cvt_pk_bf16_f32 v78, v78, v78
    v_lshlrev_b32 v78, 16, v78
    v_mul_f32 v20, v26, v78
    v_cvt_pk_bf16_f32 v20, v20, v20
    v_lshlrev_b32 v20, 16, v20
    v_lshlrev_b32 v21, 16, v118
    v_add_f32 v20, v20, v21
    v_cvt_pk_bf16_f32 v20, v20, v20
    v_lshlrev_b32 v20, 16, v20
    v_lshlrev_b32 v21, 16, v98
    v_add_f32 v20, v20, v21
    v_cvt_pk_bf16_f32 v78, v20, v20
    buffer_store_short v78, v24, s[60:63], 0 offen offset:896
    v_cvt_pk_bf16_f32 v79, v79, v79
    v_lshlrev_b32 v79, 16, v79
    v_mul_f32 v20, v26, v79
    v_cvt_pk_bf16_f32 v20, v20, v20
    v_lshlrev_b32 v20, 16, v20
    v_lshlrev_b32 v21, 16, v119
    v_add_f32 v20, v20, v21
    v_cvt_pk_bf16_f32 v20, v20, v20
    v_lshlrev_b32 v20, 16, v20
    v_lshlrev_b32 v21, 16, v99
    v_add_f32 v20, v20, v21
    v_cvt_pk_bf16_f32 v79, v20, v20
    buffer_store_short v79, v24, s[60:63], 0 offen offset:960
    v_cvt_pk_bf16_f32 v80, v80, v80
    v_lshlrev_b32 v80, 16, v80
    v_mul_f32 v20, v26, v80
    v_cvt_pk_bf16_f32 v20, v20, v20
    v_lshlrev_b32 v20, 16, v20
    v_lshlrev_b32 v21, 16, v120
    v_add_f32 v20, v20, v21
    v_cvt_pk_bf16_f32 v20, v20, v20
    v_lshlrev_b32 v20, 16, v20
    v_lshlrev_b32 v21, 16, v100
    v_add_f32 v20, v20, v21
    v_cvt_pk_bf16_f32 v80, v20, v20
    buffer_store_short v80, v24, s[60:63], 0 offen offset:1024
    v_cvt_pk_bf16_f32 v81, v81, v81
    v_lshlrev_b32 v81, 16, v81
    v_mul_f32 v20, v26, v81
    v_cvt_pk_bf16_f32 v20, v20, v20
    v_lshlrev_b32 v20, 16, v20
    v_lshlrev_b32 v21, 16, v121
    v_add_f32 v20, v20, v21
    v_cvt_pk_bf16_f32 v20, v20, v20
    v_lshlrev_b32 v20, 16, v20
    v_lshlrev_b32 v21, 16, v101
    v_add_f32 v20, v20, v21
    v_cvt_pk_bf16_f32 v81, v20, v20
    buffer_store_short v81, v24, s[60:63], 0 offen offset:1088
    v_cvt_pk_bf16_f32 v82, v82, v82
    v_lshlrev_b32 v82, 16, v82
    v_mul_f32 v20, v26, v82
    v_cvt_pk_bf16_f32 v20, v20, v20
    v_lshlrev_b32 v20, 16, v20
    v_lshlrev_b32 v21, 16, v122
    v_add_f32 v20, v20, v21
    v_cvt_pk_bf16_f32 v20, v20, v20
    v_lshlrev_b32 v20, 16, v20
    v_lshlrev_b32 v21, 16, v102
    v_add_f32 v20, v20, v21
    v_cvt_pk_bf16_f32 v82, v20, v20
    buffer_store_short v82, v24, s[60:63], 0 offen offset:1152
    v_cvt_pk_bf16_f32 v83, v83, v83
    v_lshlrev_b32 v83, 16, v83
    v_mul_f32 v20, v26, v83
    v_cvt_pk_bf16_f32 v20, v20, v20
    v_lshlrev_b32 v20, 16, v20
    v_lshlrev_b32 v21, 16, v123
    v_add_f32 v20, v20, v21
    v_cvt_pk_bf16_f32 v20, v20, v20
    v_lshlrev_b32 v20, 16, v20
    v_lshlrev_b32 v21, 16, v103
    v_add_f32 v20, v20, v21
    v_cvt_pk_bf16_f32 v83, v20, v20
    buffer_store_short v83, v24, s[60:63], 0 offen offset:1216
ffn1_kernel_done:
    s_endpgm
.section .rodata,"a"
.p2align 6
.amdhsa_kernel lnx_kernel
  .amdhsa_next_free_vgpr 48
  .amdhsa_next_free_sgpr 102
  .amdhsa_accum_offset 48
  .amdhsa_group_segment_fixed_size 0
  .amdhsa_kernarg_size 104
  .amdhsa_user_sgpr_count 2
  .amdhsa_user_sgpr_kernarg_segment_ptr 1
  .amdhsa_system_sgpr_workgroup_id_x 1
.end_amdhsa_kernel
.p2align 6
.amdhsa_kernel g1_kernel
  .amdhsa_next_free_vgpr 136
  .amdhsa_next_free_sgpr 102
  .amdhsa_accum_offset 136
  .amdhsa_group_segment_fixed_size 0
  .amdhsa_kernarg_size 104
  .amdhsa_user_sgpr_count 2
  .amdhsa_user_sgpr_kernarg_segment_ptr 1
  .amdhsa_system_sgpr_workgroup_id_x 1
.end_amdhsa_kernel
.p2align 6
.amdhsa_kernel g2_kernel
  .amdhsa_next_free_vgpr 184
  .amdhsa_next_free_sgpr 102
  .amdhsa_accum_offset 184
  .amdhsa_group_segment_fixed_size 0
  .amdhsa_kernarg_size 104
  .amdhsa_user_sgpr_count 2
  .amdhsa_user_sgpr_kernarg_segment_ptr 1
  .amdhsa_system_sgpr_workgroup_id_x 1
.end_amdhsa_kernel
.p2align 6
.amdhsa_kernel ln2_kernel
  .amdhsa_next_free_vgpr 104
  .amdhsa_next_free_sgpr 102
  .amdhsa_accum_offset 104
  .amdhsa_group_segment_fixed_size 0
  .amdhsa_kernarg_size 104
  .amdhsa_user_sgpr_count 2
  .amdhsa_user_sgpr_kernarg_segment_ptr 1
  .amdhsa_system_sgpr_workgroup_id_x 1
.end_amdhsa_kernel
.p2align 6
.amdhsa_kernel ffn1_kernel
  .amdhsa_next_free_vgpr 228
  .amdhsa_next_free_sgpr 102
  .amdhsa_accum_offset 228
  .amdhsa_group_segment_fixed_size 0
  .amdhsa_kernarg_size 104
  .amdhsa_user_sgpr_count 2
  .amdhsa_user_sgpr_kernarg_segment_ptr 1
  .amdhsa_system_sgpr_workgroup_id_x 1
.end_amdhsa_kernel
```
